```python
import torch

def _softmax(x, axis=-1):
    return torch.softmax(x, dim=axis)
def _gelu(x):
    return torch.nn.functional.gelu(x, approximate="tanh")
def _silu(x):
    return torch.nn.functional.silu(x)
def _sigmoid(x):
    return torch.sigmoid(x)
def _layernorm(x, axis=-1, eps=1e-5):
    m = x.mean(dim=axis, keepdim=True)
    v = x.var(dim=axis, keepdim=True, unbiased=False)
    return (x - m) / torch.sqrt(v + eps)
def _scatter_add(tgt, idx, src, axis=0):
    return tgt.clone().index_add_(axis, idx, src)
def _segment_sum(src, seg, n):
    out = torch.zeros((n,) + src.shape[1:], dtype=src.dtype)
    return out.index_add_(0, seg, src)
def _pad(x, pw):
    flat = tuple(v for pair in reversed(pw) for v in pair)
    return torch.nn.functional.pad(x, flat)

kernel_name = 'concat_heads__ssm_conv_s5__mha_block__prompt'

def setup_inputs():

    _w = (lambda a: (lambda t: t.to(torch.bfloat16) if t.is_floating_point() else t)(torch.as_tensor(a)))
    def _A_setup():
        B, S, D = 1, 2048, 512
        P = D
        Lambda_re = -0.5 * (lambda _x: torch.exp(torch.as_tensor(_x)))((lambda *s: torch.randn(*s, dtype=torch.bfloat16) * 0.4)(P))
        Lambda_im = (lambda *s: torch.randn(*s, dtype=torch.bfloat16) * 0.8)(P) * 1.0
        B_re = (lambda *s: torch.randn(*s, dtype=torch.bfloat16) * 0.8)(P, D) * (D ** -0.5)
        B_im = (lambda *s: torch.randn(*s, dtype=torch.bfloat16) * 0.8)(P, D) * (D ** -0.5)
        C_re = (lambda *s: torch.randn(*s, dtype=torch.bfloat16) * 0.4)(D, P) * (P ** -0.5)
        C_im = (lambda *s: torch.randn(*s, dtype=torch.bfloat16) * 0.8)(D, P) * (P ** -0.5)
        log_dt = (lambda *s: torch.randn(*s, dtype=torch.bfloat16) * 0.4)(P) * 0.3 - 2.0
        Dskip = (lambda *s: torch.randn(*s, dtype=torch.bfloat16) * 0.1)(D)
        return {
            "x": _w((lambda *s: torch.randn(*s, dtype=torch.bfloat16) * 0.05)(B, S, D)),
            "Lambda_re": _w(Lambda_re),
            "Lambda_im": _w(Lambda_im),
            "B_re": _w(B_re),
            "B_im": _w(B_im),
            "C_re": _w(C_re),
            "C_im": _w(C_im),
            "log_dt": _w(log_dt),
            "Dskip": _w(Dskip),
        }
    _A_in = _A_setup()

    def _B_setup():
        B, S, D, H = 1, 2048, 512, 32
        return {
            "x": _w((lambda *s: torch.randn(*s, dtype=torch.bfloat16) * 0.2)(B, S, D)),
            "wqkv": _w((lambda *s: torch.randn(*s, dtype=torch.bfloat16) * 0.2)(D, 3 * D)),
            "wo": _w((lambda *s: torch.randn(*s, dtype=torch.bfloat16) * 0.05)(D, D)),
        }
    _B_in = _B_setup()

    return {
        "A_x": _A_in["x"],
        "A_Lambda_re": _A_in["Lambda_re"],
        "A_Lambda_im": _A_in["Lambda_im"],
        "A_B_re": _A_in["B_re"],
        "A_B_im": _A_in["B_im"],
        "A_C_re": _A_in["C_re"],
        "A_C_im": _A_in["C_im"],
        "A_log_dt": _A_in["log_dt"],
        "A_Dskip": _A_in["Dskip"],
        "B_x": _B_in["x"],
        "B_wqkv": _B_in["wqkv"],
        "B_wo": _B_in["wo"],
    }

def reference(A_x, A_Lambda_re, A_Lambda_im, A_B_re, A_B_im, A_C_re, A_C_im, A_log_dt, A_Dskip, B_x, B_wqkv, B_wo):
    def _A_ref(x, Lambda_re, Lambda_im, B_re, B_im, C_re, C_im, log_dt, Dskip):
        Bsz, L, H = x.shape
        Lam = Lambda_re + 1j * Lambda_im
        Bmat = B_re + 1j * B_im
        Cmat = C_re + 1j * C_im
        dt = torch.exp(log_dt)
        Lam_bar = torch.exp(dt * Lam)
        B_bar = ((Lam_bar - 1.0) / Lam)[:, None] * Bmat
        Bu = torch.einsum("bld,pd->blp", x + 0j, B_bar)
        h = torch.zeros_like(Bu[:, 0, :])
        hs = []
        for t in range(L):
            h = Lam_bar[None, :] * h + Bu[:, t, :]
            hs.append(h)
        hseq = torch.stack(hs, 1)
        y = 2.0 * torch.einsum("blp,dp->bld", hseq, Cmat).real + x * Dskip[None, None, :]
        return y

    def _B_ref(x, wqkv, wo):
        B, S, D = x.shape
        H = 32
        Dh = D // H
        qkv = (lambda x, *d: x.permute(*d))((x @ wqkv).reshape(B, S, 3, H, Dh), 2, 0, 3, 1, 4)
        q, k, v = qkv[0], qkv[1], qkv[2]
        scores = torch.einsum("bhqd,bhkd->bhqk", q, k) * (Dh ** -0.5)
        p = _softmax(scores, axis=-1)
        o = torch.einsum("bhqk,bhkd->bhqd", p, v)
        return (lambda x, *d: x.permute(*d))(o, 0, 2, 1, 3).reshape(B, S, D) @ wo

    a = _A_ref(A_x, A_Lambda_re, A_Lambda_im, A_B_re, A_B_im, A_C_re, A_C_im, A_log_dt, A_Dskip)
    b = _B_ref(B_x, B_wqkv, B_wo)
    return torch.concatenate([a, b], axis=-1)
```

```asm
; @launch grid=(256,1,1) block=(768,1,1) lds=163840
.amdgcn_target "amdgcn-amd-amdhsa--gfx950"
.text
.globl concat_heads__ssm_conv_s5__mha_block__prompt_kernel
.p2align 8
.type concat_heads__ssm_conv_s5__mha_block__prompt_kernel,@function
concat_heads__ssm_conv_s5__mha_block__prompt_kernel:
L_START:
    s_cmp_ge_u32 s2, 0x100
    s_cbranch_scc1 L_END
    s_load_dwordx2 s[4:5], s[0:1], 72
    s_load_dwordx2 s[8:9], s[0:1], 80
    s_load_dwordx2 s[12:13], s[0:1], 112
    s_load_dwordx16 s[64:79], s[0:1], 0
    s_load_dwordx2 s[80:81], s[0:1], 64
    s_load_dwordx4 s[84:87], s[0:1], 88
    v_lshrrev_b32 v2, 6, v0
    v_and_b32 v1, 63, v0
    s_and_b32 s16, s2, 7
    v_readfirstlane_b32 s3, v2
    s_lshr_b32 s17, s2, 3
    s_and_b32 s18, s17, 3
    s_lshr_b32 s19, s17, 2
    s_mov_b32 s6, 0x200000
    s_mov_b32 s7, 0x20000
    s_mov_b32 s10, 0x180000
    s_mov_b32 s11, 0x20000
    s_mov_b32 s14, 15728640
    s_mov_b32 s15, 0x20000
    s_getreg_b32 s46, hwreg(HW_REG_XCC_ID, 0, 4)
    s_getpc_b64 s[82:83]
L_PC:
    s_sub_u32 s82, s82, L_PC-L_START
    s_subb_u32 s83, s83, 0
    s_lshl_b32 s23, s3, 5
    s_add_u32 s23, s23, s17
    s_lshl_b32 s23, s23, 7
    s_cmp_ge_u32 s23, L_CODE_END-L_START
    s_cbranch_scc1 L_NOPF
    v_mov_b32 v3, s23
    s_mov_b64 exec, 1
    global_load_dword v163, v3, s[82:83]
    s_mov_b64 exec, -1
L_NOPF:
    s_cmp_ge_u32 s3, 8
    s_cbranch_scc0 L_ATT
    s_sub_u32 s48, s3, 8
    s_setprio 3
    v_lshrrev_b32 v25, 3, v1
    v_lshrrev_b32 v2, 4, v1
    s_and_b32 s23, s48, 1
    s_lshl_b32 s23, s23, 2
    v_add_u32 v2, s23, v2
    v_xor_b32 v2, v2, v1
    v_and_b32 v2, 7, v2
    v_lshlrev_b32 v2, 4, v2
    v_lshrrev_b32 v26, 4, v1
    v_and_b32 v26, 1, v26
    v_lshlrev_b32 v27, 2, v26
    v_xor_b32 v27, v27, v1
    v_and_b32 v27, 7, v27
    v_lshlrev_b32 v27, 4, v27
    v_mul_u32_u24 v4, 3072, v25
    v_add_u32 v4, v4, v27
    v_add_u32 v5, 47104, v4
    v_mov_b32 v28, v2
    v_lshl_add_u32 v2, v25, 10, v2
    v_add_u32 v3, 14336, v2
    s_and_b32 s28, s48, 1
    s_lshr_b32 s24, s48, 1
    s_lshl_b32 s24, s24, 2
    s_add_u32 s49, s28, s24
    s_lshl_b32 s23, s16, 2
    s_add_u32 s23, s23, s18
    s_lshl_b32 s23, s23, 16
    s_lshl_b32 s24, s49, 13
    s_add_u32 s53, s23, s24
    s_mul_i32 s23, s49, 24576
    s_add_u32 s24, s19, 2
    s_and_b32 s24, s24, 7
    s_lshl_b32 s24, s24, 7
    s_add_u32 s54, s23, s24
    s_lshl_b32 s52, s49, 10
    s_mov_b32 s56, s52
    s_add_u32 s57, s52, 65536
    s_add_u32 s55, s16, s19
    s_and_b32 s55, s55, 7
    s_lshl_b32 s30, s55, 7
    s_mul_i32 s31, s55, 196608
    s_mul_i32 s23, s49, 24576
    s_lshl_b32 s24, s19, 7
    s_add_u32 s50, s23, s24
    s_add_u32 s50, s50, 1024
    s_add_u32 s24, s19, 4
    s_and_b32 s24, s24, 7
    s_lshl_b32 s24, s24, 7
    s_add_u32 s51, s23, s24
    s_add_u32 s51, s51, 2048
    s_mov_b32 s58, 0
    s_waitcnt lgkmcnt(0)
    s_mov_b32 m0, s56
    s_add_u32 s23, s53, s30
    buffer_load_dwordx4 v2, s[4:7], s23 offen lds
    buffer_load_dwordx4 v3, s[4:7], s23 offen offset:2048 lds
    s_add_u32 s56, s56, 8192
    s_add_u32 s30, s30, 128
    s_and_b32 s30, s30, 1023
    s_mov_b32 m0, s57
    s_add_u32 s23, s50, s31
    buffer_load_dwordx4 v4, s[8:11], s23 offen lds
    buffer_load_dwordx4 v5, s[8:11], s23 offen offset:2048 lds
    s_add_u32 s57, s57, 8192
    s_mov_b32 m0, s57
    s_add_u32 s23, s51, s31
    buffer_load_dwordx4 v4, s[8:11], s23 offen lds
    buffer_load_dwordx4 v5, s[8:11], s23 offen offset:2048 lds
    s_add_u32 s57, s57, 8192
    s_mov_b32 m0, s57
    s_add_u32 s23, s54, s31
    buffer_load_dwordx4 v4, s[8:11], s23 offen lds
    buffer_load_dwordx4 v5, s[8:11], s23 offen offset:2048 lds
    s_add_u32 s57, s57, 8192
    s_add_u32 s31, s31, 196608
    s_cmp_eq_u32 s31, 1572864
    s_cselect_b32 s31, 0, s31
    s_load_dword s21, s[12:13], 0
    v_and_b32 v29, 31, v1
    s_lshr_b32 s23, s17, 1
    s_lshl_b32 s23, s23, 6
    v_lshl_add_u32 v29, v29, 1, s23
    global_load_ushort v20, v29, s[66:67]
    global_load_ushort v21, v29, s[68:69]
    global_load_ushort v22, v29, s[78:79]
    s_lshl_b32 s23, s16, 3
    s_add_u32 s23, s23, s19
    s_lshl_b32 s23, s23, 7
    s_add_u32 s23, s23, 16384
    v_lshlrev_b32 v29, 21, v1
    v_writelane_b32 v29, s23, 0
    s_mov_b64 exec, 1
    buffer_load_dword v162, v29, s[12:15], 0 offen sc1
    s_mov_b64 exec, -1
    s_mov_b32 m0, s56
    s_add_u32 s23, s53, s30
    buffer_load_dwordx4 v2, s[4:7], s23 offen lds
    buffer_load_dwordx4 v3, s[4:7], s23 offen offset:2048 lds
    s_add_u32 s56, s56, 8192
    s_add_u32 s30, s30, 128
    s_and_b32 s30, s30, 1023
    s_mov_b32 m0, s57
    s_add_u32 s23, s50, s31
    buffer_load_dwordx4 v4, s[8:11], s23 offen lds
    buffer_load_dwordx4 v5, s[8:11], s23 offen offset:2048 lds
    s_add_u32 s57, s57, 8192
    s_mov_b32 m0, s57
    s_add_u32 s23, s51, s31
    buffer_load_dwordx4 v4, s[8:11], s23 offen lds
    buffer_load_dwordx4 v5, s[8:11], s23 offen offset:2048 lds
    s_add_u32 s57, s57, 8192
    v_lshrrev_b32 v25, 3, v1
    v_lshrrev_b32 v27, 2, v25
    v_lshlrev_b32 v27, 4, v27
    v_add_u32 v27, v27, v26
    v_and_b32 v25, 1, v25
    v_lshl_add_u32 v27, v25, 3, v27
    v_lshl_add_u32 v6, v27, 10, v28
    v_add_u32 v7, 2048, v6
    s_lshl_b32 s23, s16, 1
    s_and_b32 s24, s17, 1
    s_add_u32 s26, s23, s24
    s_lshr_b32 s27, s17, 1
    v_and_b32 v25, 31, v1
    v_lshrrev_b32 v26, 1, v25
    v_lshrrev_b32 v32, 5, v1
    v_xor_b32 v26, v26, v32
    v_and_b32 v26, 7, v26
    v_lshlrev_b32 v26, 4, v26
    v_lshl_add_u32 v32, v25, 7, v26
    v_xor_b32 v33, 32, v32
    v_xor_b32 v34, 64, v32
    v_xor_b32 v35, 96, v32
    s_lshl_b32 s23, s48, 12
    s_add_u32 s23, s23, 90112
    v_add_u32 v36, s23, v32
    v_add_u32 v32, 81920, v32
    v_add_u32 v37, s23, v33
    v_add_u32 v33, 81920, v33
    v_add_u32 v38, s23, v34
    v_add_u32 v34, 81920, v34
    v_add_u32 v39, s23, v35
    v_add_u32 v35, 81920, v35
    s_lshl_b32 s23, s48, 12
    s_add_u32 s34, s23, 131072
    v_and_b32 v145, 31, v1
    v_lshlrev_b32 v145, 4, v145
    v_mov_b32 v146, 156672
    v_mov_b32 v147, 1
    v_and_b32 v25, 31, v1
    v_lshrrev_b32 v26, 5, v1
    v_lshlrev_b32 v148, 3, v25
    v_add_u32 v148, 155648, v148
    s_lshl_b32 s23, s48, 8
    v_add_u32 v149, s23, v148
    s_lshl_b32 s23, s27, 9
    v_lshl_add_u32 v150, v25, 4, s23
    s_sub_u32 s23, 16, s26
    s_lshl_b32 s23, s23, 13
    v_lshl_add_u32 v27, v26, 16, v150
    v_add_u32 v151, s23, v27
    v_lshlrev_b32 v27, 5, v26
    v_lshl_add_u32 v27, v25, 6, v27
    v_add_u32 v152, s34, v27
    v_bfe_u32 v27, v1, 2, 2
    v_lshl_add_u32 v27, v26, 3, v27
    v_lshlrev_b32 v27, 6, v27
    v_bfe_u32 v28, v1, 4, 1
    v_lshl_add_u32 v27, v28, 5, v27
    v_and_b32 v28, 3, v1
    v_lshl_add_u32 v27, v28, 3, v27
    v_add_u32 v153, s34, v27
    v_and_b32 v27, 3, v1
    v_bfe_u32 v28, v1, 2, 1
    v_lshlrev_b32 v28, 6, v28
    v_lshl_add_u32 v154, v27, 2, v28
    v_xor_b32 v26, v26, v25
    v_and_b32 v26, 7, v26
    v_lshlrev_b32 v26, 4, v26
    v_lshl_add_u32 v26, v25, 7, v26
    v_add_u32 v157, s34, v26
    s_lshl_b32 s23, s16, 2
    s_add_u32 s23, s23, s18
    s_lshl_b32 s23, s23, 1
    s_add_u32 s32, s23, s28
    s_lshl_b32 s23, s19, 1
    s_lshr_b32 s24, s48, 1
    s_add_u32 s33, s23, s24
    v_lshrrev_b32 v25, 3, v1
    v_and_b32 v26, 7, v1
    s_lshl_b32 s23, s32, 15
    s_lshl_b32 s24, s33, 6
    s_add_u32 s23, s23, s24
    v_lshlrev_b32 v27, 10, v25
    v_lshl_add_u32 v27, v26, 3, v27
    v_add_u32 v155, s23, v27
    v_lshl_add_u32 v156, v26, 3, s24
    v_xor_b32 v27, v25, v26
    v_lshlrev_b32 v27, 4, v27
    v_lshl_add_u32 v27, v25, 7, v27
    v_add_u32 v158, s34, v27
    v_lshlrev_b32 v27, 12, v25
    v_lshl_add_u32 v159, v26, 4, v27
    s_lshl_b32 s23, s26, 2
    s_add_u32 s92, s23, s48
    s_lshl_b32 s23, s92, 16
    s_lshl_b32 s24, s27, 12
    s_add_u32 s23, s23, s24
    s_add_u32 s93, s23, 8388608
    s_lshl_b32 s23, s92, 6
    s_add_u32 s94, s23, 36864
    s_mov_b32 m0, s57
    s_add_u32 s23, s54, s31
    buffer_load_dwordx4 v4, s[8:11], s23 offen lds
    buffer_load_dwordx4 v5, s[8:11], s23 offen offset:2048 lds
    s_add_u32 s57, s57, 8192
    s_add_u32 s31, s31, 196608
    s_cmp_eq_u32 s31, 1572864
    s_cselect_b32 s31, 0, s31
    s_mov_b32 m0, s56
    s_add_u32 s23, s53, s30
    buffer_load_dwordx4 v2, s[4:7], s23 offen lds
    buffer_load_dwordx4 v3, s[4:7], s23 offen offset:2048 lds
    s_add_u32 s56, s56, 8192
    s_add_u32 s30, s30, 128
    s_and_b32 s30, s30, 1023
    s_mov_b32 m0, s57
    s_add_u32 s23, s50, s31
    buffer_load_dwordx4 v4, s[8:11], s23 offen lds
    buffer_load_dwordx4 v5, s[8:11], s23 offen offset:2048 lds
    s_add_u32 s57, s57, 8192
    s_waitcnt vmcnt(16)
    s_barrier
    s_mov_b32 m0, s57
    s_add_u32 s23, s51, s31
    buffer_load_dwordx4 v4, s[8:11], s23 offen lds
    buffer_load_dwordx4 v5, s[8:11], s23 offen offset:2048 lds
    s_add_u32 s57, s57, 8192
    s_mov_b32 m0, s57
    s_add_u32 s23, s54, s31
    buffer_load_dwordx4 v4, s[8:11], s23 offen lds
    buffer_load_dwordx4 v5, s[8:11], s23 offen offset:2048 lds
    s_add_u32 s57, s57, 8192
    s_add_u32 s31, s31, 196608
    s_cmp_eq_u32 s31, 1572864
    s_cselect_b32 s31, 0, s31
    s_mov_b32 m0, s56
    s_add_u32 s23, s53, s30
    buffer_load_dwordx4 v2, s[4:7], s23 offen lds
    buffer_load_dwordx4 v3, s[4:7], s23 offen offset:2048 lds
    s_add_u32 s56, s56, 8192
    s_add_u32 s30, s30, 128
    s_and_b32 s30, s30, 1023
    s_mov_b32 m0, s57
    s_add_u32 s23, s50, s31
    buffer_load_dwordx4 v4, s[8:11], s23 offen lds
    buffer_load_dwordx4 v5, s[8:11], s23 offen offset:2048 lds
    s_add_u32 s57, s57, 8192
    s_waitcnt vmcnt(12)
    s_barrier
    s_mov_b32 m0, s57
    s_add_u32 s23, s51, s31
    buffer_load_dwordx4 v4, s[8:11], s23 offen lds
    buffer_load_dwordx4 v5, s[8:11], s23 offen offset:2048 lds
    s_add_u32 s57, s57, 8192
    s_mov_b32 m0, s57
    s_add_u32 s23, s54, s31
    buffer_load_dwordx4 v4, s[8:11], s23 offen lds
    buffer_load_dwordx4 v5, s[8:11], s23 offen offset:2048 lds
    s_add_u32 s57, s57, 8192
    s_add_u32 s31, s31, 196608
    s_cmp_eq_u32 s31, 1572864
    s_cselect_b32 s31, 0, s31
    s_mov_b32 m0, s56
    s_add_u32 s23, s53, s30
    buffer_load_dwordx4 v2, s[4:7], s23 offen lds
    buffer_load_dwordx4 v3, s[4:7], s23 offen offset:2048 lds
    s_add_u32 s56, s56, 8192
    s_add_u32 s30, s30, 128
    s_and_b32 s30, s30, 1023
    s_sub_u32 s57, s57, 98304
    s_mov_b32 m0, s57
    s_add_u32 s23, s50, s31
    buffer_load_dwordx4 v4, s[8:11], s23 offen lds
    buffer_load_dwordx4 v5, s[8:11], s23 offen offset:2048 lds
    s_add_u32 s57, s57, 8192
    v_lshlrev_b32 v20, 16, v20
    v_lshlrev_b32 v21, 16, v21
    v_lshlrev_b32 v22, 16, v22
    v_mul_f32 v22, 0x3fb8aa3b, v22
    v_exp_f32 v22, v22
    s_nop 0
    v_cvt_pk_bf16_f32 v22, v22, v22
    v_and_b32 v22, 0xffff0000, v22
    v_mul_f32 v25, v22, v20
    v_mul_f32 v26, v22, v21
    v_mul_f32 v25, 0x3fb8aa3b, v25
    v_mul_f32 v26, 0.15915494, v26
    v_exp_f32 v25, v25
    v_rndne_f32 v27, v26
    v_sub_f32 v26, v26, v27
    v_cos_f32 v8, v26
    v_sin_f32 v9, v26
    s_nop 0
    v_mul_f32 v8, v8, v25
    v_mul_f32 v9, v9, v25
    s_waitcnt vmcnt(12)
    s_barrier
    s_mov_b32 m0, s57
    s_add_u32 s23, s51, s31
    buffer_load_dwordx4 v4, s[8:11], s23 offen lds
    buffer_load_dwordx4 v5, s[8:11], s23 offen offset:2048 lds
    s_add_u32 s57, s57, 8192
    s_mov_b32 m0, s57
    s_add_u32 s23, s54, s31
    buffer_load_dwordx4 v4, s[8:11], s23 offen lds
    buffer_load_dwordx4 v5, s[8:11], s23 offen offset:2048 lds
    s_add_u32 s57, s57, 8192
    s_add_u32 s31, s31, 196608
    s_cmp_eq_u32 s31, 1572864
    s_cselect_b32 s31, 0, s31
    s_mov_b32 m0, s56
    s_add_u32 s23, s53, s30
    buffer_load_dwordx4 v2, s[4:7], s23 offen lds
    buffer_load_dwordx4 v3, s[4:7], s23 offen offset:2048 lds
    s_add_u32 s56, s56, 8192
    s_add_u32 s30, s30, 128
    s_and_b32 s30, s30, 1023
    s_mov_b32 m0, s57
    s_add_u32 s23, s50, s31
    buffer_load_dwordx4 v4, s[8:11], s23 offen lds
    buffer_load_dwordx4 v5, s[8:11], s23 offen offset:2048 lds
    s_add_u32 s57, s57, 8192
    v_mul_f32 v25, v9, v9
    v_mul_f32 v26, v8, v9
    v_fma_f32 v10, v8, v8, -v25
    v_add_f32 v11, v26, v26
    v_mul_f32 v25, v11, v11
    v_mul_f32 v26, v10, v11
    v_fma_f32 v10, v10, v10, -v25
    v_add_f32 v11, v26, v26
    v_mul_f32 v25, v11, v11
    v_mul_f32 v26, v10, v11
    v_fma_f32 v10, v10, v10, -v25
    v_add_f32 v11, v26, v26
    v_mul_f32 v25, v11, v11
    v_mul_f32 v26, v10, v11
    v_fma_f32 v12, v10, v10, -v25
    v_add_f32 v13, v26, v26
    v_mul_f32 v25, v13, v13
    v_mul_f32 v26, v12, v13
    v_fma_f32 v14, v12, v12, -v25
    v_add_f32 v15, v26, v26
    s_waitcnt vmcnt(12)
    s_barrier
    s_mov_b32 m0, s57
    s_add_u32 s23, s51, s31
    buffer_load_dwordx4 v4, s[8:11], s23 offen lds
    buffer_load_dwordx4 v5, s[8:11], s23 offen offset:2048 lds
    s_add_u32 s57, s57, 8192
    s_mov_b32 m0, s57
    s_add_u32 s23, s54, s31
    buffer_load_dwordx4 v4, s[8:11], s23 offen lds
    buffer_load_dwordx4 v5, s[8:11], s23 offen offset:2048 lds
    s_add_u32 s57, s57, 8192
    s_add_u32 s31, s31, 196608
    s_cmp_eq_u32 s31, 1572864
    s_cselect_b32 s31, 0, s31
    s_mov_b32 m0, s56
    s_add_u32 s23, s53, s30
    buffer_load_dwordx4 v2, s[4:7], s23 offen lds
    buffer_load_dwordx4 v3, s[4:7], s23 offen offset:2048 lds
    s_add_u32 s56, s56, 8192
    s_add_u32 s30, s30, 128
    s_and_b32 s30, s30, 1023
    s_mov_b32 m0, s57
    s_add_u32 s23, s50, s31
    buffer_load_dwordx4 v4, s[8:11], s23 offen lds
    buffer_load_dwordx4 v5, s[8:11], s23 offen offset:2048 lds
    s_add_u32 s57, s57, 8192
    v_mul_f32 v25, v15, v15
    v_mul_f32 v26, v14, v15
    v_fma_f32 v16, v14, v14, -v25
    v_add_f32 v17, v26, v26
    v_mul_f32 v25, v17, v17
    v_mul_f32 v26, v16, v17
    v_fma_f32 v16, v16, v16, -v25
    v_add_f32 v17, v26, v26
    v_mul_f32 v25, v17, v17
    v_mul_f32 v26, v16, v17
    v_fma_f32 v18, v16, v16, -v25
    v_add_f32 v19, v26, v26
    v_mul_f32 v25, v19, v19
    v_mul_f32 v26, v18, v19
    v_fma_f32 v18, v18, v18, -v25
    v_add_f32 v19, v26, v26
    v_mul_f32 v25, v19, v19
    v_mul_f32 v26, v18, v19
    v_fma_f32 v18, v18, v18, -v25
    v_add_f32 v19, v26, v26
    s_waitcnt lgkmcnt(0)
    s_mul_i32 s20, s21, 0x9E3779B1
    s_add_u32 s20, s20, 0x7F4A7C15
    s_waitcnt vmcnt(12)
    s_barrier
    s_mov_b32 m0, s57
    s_add_u32 s23, s51, s31
    buffer_load_dwordx4 v4, s[8:11], s23 offen lds
    buffer_load_dwordx4 v5, s[8:11], s23 offen offset:2048 lds
    s_add_u32 s57, s57, 8192
    s_mov_b32 m0, s57
    s_add_u32 s23, s54, s31
    buffer_load_dwordx4 v4, s[8:11], s23 offen lds
    buffer_load_dwordx4 v5, s[8:11], s23 offen offset:2048 lds
    s_add_u32 s57, s57, 8192
    s_add_u32 s31, s31, 196608
    s_cmp_eq_u32 s31, 1572864
    s_cselect_b32 s31, 0, s31
    s_mov_b32 m0, s56
    s_add_u32 s23, s53, s30
    buffer_load_dwordx4 v2, s[4:7], s23 offen lds
    buffer_load_dwordx4 v3, s[4:7], s23 offen offset:2048 lds
    s_add_u32 s56, s56, 8192
    s_add_u32 s30, s30, 128
    s_and_b32 s30, s30, 1023
    s_mov_b32 m0, s57
    s_add_u32 s23, s50, s31
    buffer_load_dwordx4 v4, s[8:11], s23 offen lds
    buffer_load_dwordx4 v5, s[8:11], s23 offen offset:2048 lds
    s_add_u32 s57, s57, 8192
    v_lshlrev_b32 v25, 2, v1
    v_add_u32 v25, 156672, v25
    v_mov_b32 v26, 0
    v_writelane_b32 v26, 8, 1
    v_writelane_b32 v26, 8, 2
    v_writelane_b32 v26, 8, 3
    v_writelane_b32 v26, 8, 4
    v_writelane_b32 v26, 8, 5
    v_writelane_b32 v26, 8, 6
    v_writelane_b32 v26, 8, 7
    v_writelane_b32 v26, 12, 8
    ds_write_b32 v25, v26
    s_waitcnt vmcnt(12) lgkmcnt(0)
    s_barrier
    s_mov_b32 m0, s57
    s_add_u32 s23, s51, s31
    buffer_load_dwordx4 v4, s[8:11], s23 offen lds
    buffer_load_dwordx4 v5, s[8:11], s23 offen offset:2048 lds
    s_add_u32 s57, s57, 8192
    s_sub_u32 s57, s57, 90112
    s_mov_b32 m0, s57
    s_add_u32 s23, s54, s31
    buffer_load_dwordx4 v4, s[8:11], s23 offen lds
    buffer_load_dwordx4 v5, s[8:11], s23 offen offset:2048 lds
    s_add_u32 s57, s57, 8192
    s_add_u32 s31, s31, 196608
    s_cmp_eq_u32 s31, 1572864
    s_cselect_b32 s31, 0, s31
    v_add_f32 v25, -1.0, v8
    v_mul_f32 v26, v20, v20
    v_fmac_f32 v26, v21, v21
    v_rcp_f32 v26, v26
    v_mul_f32 v23, v25, v20
    v_mul_f32 v24, v9, v20
    v_add_f32 v26, v26, v26
    v_fmac_f32 v23, v9, v21
    v_fma_f32 v24, -v25, v21, v24
    v_mul_f32 v23, v23, v26
    v_mul_f32 v24, v24, v26
    v_xor_b32 v24, 0x80000000, v24
    s_cmp_lt_u32 s48, 2
    s_cbranch_scc1 L_CP0
    v_xor_b32 v26, 0x80000000, v23
    v_mov_b32 v23, v24
    v_mov_b32 v24, v26
L_CP0:
    s_lshl_b32 s23, s16, 1
    s_and_b32 s24, s17, 1
    s_add_u32 s26, s23, s24
    s_lshr_b32 s27, s17, 1
    s_lshl_b32 s23, s26, 15
    s_lshl_b32 s24, s27, 6
    s_add_u32 s23, s23, s24
    s_and_b32 s28, s48, 1
    s_lshl_b32 s24, s28, 5
    s_add_u32 s23, s23, s24
    v_and_b32 v25, 31, v1
    v_lshrrev_b32 v26, 5, v1
    v_lshlrev_b32 v27, 4, v26
    v_lshl_add_u32 v27, v25, 10, v27
    v_add_u32 v27, s23, v27
    s_lshr_b32 s29, s48, 1
    s_lshl_b32 s23, s27, 1
    s_add_u32 s29, s29, s23
    s_lshl_b32 s23, s29, 14
    s_lshl_b32 s24, s26, 6
    s_add_u32 s23, s23, s24
    s_lshl_b32 s24, s28, 13
    s_add_u32 s23, s23, s24
    v_lshlrev_b32 v28, 12, v26
    v_lshl_add_u32 v28, v25, 1, v28
    v_add_u32 v28, s23, v28
    v_lshlrev_b32 v29, 5, v26
    s_lshl_b32 s24, s28, 6
    v_add_u32 v29, s24, v29
    ds_bpermute_b32 v128, v29, v23 offset:0
    ds_bpermute_b32 v129, v29, v23 offset:4
    ds_bpermute_b32 v130, v29, v23 offset:8
    ds_bpermute_b32 v131, v29, v23 offset:12
    ds_bpermute_b32 v132, v29, v23 offset:16
    ds_bpermute_b32 v133, v29, v23 offset:20
    ds_bpermute_b32 v134, v29, v23 offset:24
    ds_bpermute_b32 v135, v29, v23 offset:28
    v_mov_b32 v160, v27
    v_mov_b32 v161, v28
    v_lshlrev_b32 v144, 4, v1
    s_waitcnt vmcnt(8)
    s_barrier
    s_waitcnt lgkmcnt(0)
    ds_bpermute_b32 v136, v29, v24 offset:0
    ds_bpermute_b32 v137, v29, v24 offset:4
    ds_bpermute_b32 v138, v29, v24 offset:8
    ds_bpermute_b32 v139, v29, v24 offset:12
    ds_bpermute_b32 v140, v29, v24 offset:16
    ds_bpermute_b32 v141, v29, v24 offset:20
    ds_bpermute_b32 v142, v29, v24 offset:24
    ds_bpermute_b32 v143, v29, v24 offset:28
    s_mov_b32 s40, s64
    s_mov_b32 s41, s65
    s_mov_b32 s42, 0x200000
    s_mov_b32 s43, 0x20000
    s_cmp_lt_u32 s48, 2
    s_cselect_b32 s36, s70, s72
    s_cselect_b32 s37, s71, s73
    s_mov_b32 s38, 0x80000
    s_mov_b32 s39, 0x20000
    s_lshl_b32 s23, s26, 17
    s_lshr_b32 s24, s48, 1
    s_lshl_b32 s24, s24, 15
    s_add_u32 s23, s23, s24
    s_lshl_b32 s24, s28, 11
    s_add_u32 s59, s23, s24
    s_lshl_b32 s23, s27, 15
    s_lshl_b32 s24, s28, 13
    s_add_u32 s60, s23, s24
    s_add_u32 s35, s16, s27
    s_and_b32 s35, s35, 7
    s_lshl_b32 s35, s35, 7
    v_and_b32 v25, 31, v1
    v_lshlrev_b32 v25, 3, v25
    s_lshl_b32 s23, s16, 8
    s_add_u32 s23, s23, 4096
    buffer_load_dwordx2 v[30:31], v25, s[12:15], s23 offen sc1
    s_waitcnt vmcnt(1)
    s_barrier
    s_lshl_b32 s23, s19, 10
    s_add_u32 s50, s23, 8192
    v_and_b32 v25, 7, v1
    v_lshrrev_b32 v26, 3, v1
    v_lshlrev_b32 v26, 5, v26
    v_add_lshl_u32 v165, v25, v26, 2
    s_mov_b64 s[62:63], 0
    s_lshl_b32 s61, s17, 17
    s_lshl_b32 s23, s48, 12
    s_add_u32 s61, s61, s23
    s_add_u32 s61, s61, 2097152
    s_mov_b32 s51, s23
    s_barrier
    s_waitcnt vmcnt(0) lgkmcnt(0)
    v_cmp_eq_u32 s[24:25], s20, v30
    v_cmp_eq_u32 vcc, s46, v31
    s_nop 1
    s_and_b64 vcc, vcc, s[24:25]
    s_cmp_eq_u64 vcc, -1
    s_cselect_b32 s22, 1, 0
    s_waitcnt lgkmcnt(0)
    s_barrier
    s_add_u32 s30, s16, 1
    s_and_b32 s30, s30, 7
    s_lshl_b32 s31, s30, 3
    s_mov_b32 s47, 0
L_rb1:
    s_lshr_b64 s[24:25], s[62:63], s31
    s_and_b32 s24, s24, 0xff
    s_cmp_eq_u32 s24, 0xff
    s_cbranch_scc1 L_rb1g
    buffer_load_dword v26, v165, s[12:15], s50 offen sc1
    s_add_u32 s47, s47, 1
    s_cmp_gt_u32 s47, 2097152
    s_cbranch_scc1 L_rb1g
    s_waitcnt vmcnt(0)
    v_cmp_eq_u32 s[62:63], s20, v26
    s_nop 1
    s_branch L_rb1
L_rb1g:
    s_lshl_b32 s30, s30, 14
    s_add_u32 m0, s51, 16384
    s_add_u32 s30, s30, s61
    buffer_load_dwordx4 v144, s[12:15], s30 offen offset:0 sc1 lds
    buffer_load_dwordx4 v144, s[12:15], s30 offen offset:1024 sc1 lds
    buffer_load_dwordx4 v144, s[12:15], s30 offen offset:2048 sc1 lds
    buffer_load_dwordx4 v144, s[12:15], s30 offen offset:3072 sc1 lds
    s_add_u32 m0, s52, 106496
    s_add_u32 s95, s60, s35
    buffer_load_dwordx4 v2, s[36:39], s95 offen lds
    buffer_load_dwordx4 v3, s[36:39], s95 offen offset:2048 lds
    s_add_u32 m0, s52, 114688
    s_add_u32 s95, s59, s35
    buffer_load_dwordx4 v6, s[40:43], s95 offen lds
    buffer_load_dwordx4 v7, s[40:43], s95 offen offset:2048 lds
    s_add_u32 m0, s52, 122880
    s_add_u32 s95, s95, 65536
    buffer_load_dwordx4 v6, s[40:43], s95 offen lds
    buffer_load_dwordx4 v7, s[40:43], s95 offen offset:2048 lds
    s_add_u32 s35, s35, 128
    s_and_b32 s35, s35, 1023
    s_waitcnt vmcnt(6)
    s_mov_b64 exec, 1
    ds_add_u32 v146, v147 offset:4
    s_mov_b64 exec, -1
    s_add_u32 m0, s52, 131072
    s_add_u32 s95, s60, s35
    buffer_load_dwordx4 v2, s[36:39], s95 offen lds
    buffer_load_dwordx4 v3, s[36:39], s95 offen offset:2048 lds
    s_add_u32 m0, s52, 139264
    s_add_u32 s95, s59, s35
    buffer_load_dwordx4 v6, s[40:43], s95 offen lds
    buffer_load_dwordx4 v7, s[40:43], s95 offen offset:2048 lds
    s_add_u32 m0, s52, 147456
    s_add_u32 s95, s95, 65536
    buffer_load_dwordx4 v6, s[40:43], s95 offen lds
    buffer_load_dwordx4 v7, s[40:43], s95 offen offset:2048 lds
    s_add_u32 s35, s35, 128
    s_and_b32 s35, s35, 1023
    s_waitcnt vmcnt(6)
    s_mov_b64 exec, 1
    ds_add_u32 v146, v147 offset:44
    s_mov_b64 exec, -1
    s_add_u32 s30, s16, 2
    s_and_b32 s30, s30, 7
    s_lshl_b32 s31, s30, 3
    s_mov_b32 s47, 0
L_rb2:
    s_lshr_b64 s[24:25], s[62:63], s31
    s_and_b32 s24, s24, 0xff
    s_cmp_eq_u32 s24, 0xff
    s_cbranch_scc1 L_rb2g
    buffer_load_dword v26, v165, s[12:15], s50 offen sc1
    s_add_u32 s47, s47, 1
    s_cmp_gt_u32 s47, 2097152
    s_cbranch_scc1 L_rb2g
    s_waitcnt vmcnt(0)
    v_cmp_eq_u32 s[62:63], s20, v26
    s_nop 1
    s_branch L_rb2
L_rb2g:
    s_lshl_b32 s30, s30, 14
    s_add_u32 m0, s51, 32768
    s_add_u32 s30, s30, s61
    buffer_load_dwordx4 v144, s[12:15], s30 offen offset:0 sc1 lds
    buffer_load_dwordx4 v144, s[12:15], s30 offen offset:1024 sc1 lds
    buffer_load_dwordx4 v144, s[12:15], s30 offen offset:2048 sc1 lds
    buffer_load_dwordx4 v144, s[12:15], s30 offen offset:3072 sc1 lds
    s_mov_b32 s47, 0
L_hb3:
    ds_read_b32 v25, v146 offset:44
    s_add_u32 s47, s47, 1
    s_cmp_gt_u32 s47, 2097152
    s_cbranch_scc1 L_hd4
    s_waitcnt lgkmcnt(0)
    v_cmp_gt_u32 vcc, 4, v25
    s_nop 1
    s_cbranch_vccz L_hd4
    s_branch L_hb3
L_hd4:
    ds_read_b128 v[80:83], v36 offset:24576
    ds_read_b128 v[84:87], v32 offset:24576
    ds_read_b128 v[88:91], v32 offset:28672
    s_add_u32 m0, s52, 81920
    s_add_u32 s95, s60, s35
    buffer_load_dwordx4 v2, s[36:39], s95 offen lds
    buffer_load_dwordx4 v3, s[36:39], s95 offen offset:2048 lds
    s_waitcnt lgkmcnt(0)
    v_mfma_f32_32x32x16_bf16 v[96:111], v[80:83], v[84:87], 0
    v_mfma_f32_32x32x16_bf16 v[112:127], v[80:83], v[88:91], 0
    ds_read_b128 v[80:83], v37 offset:24576
    ds_read_b128 v[84:87], v33 offset:24576
    ds_read_b128 v[88:91], v33 offset:28672
    s_add_u32 m0, s52, 90112
    s_add_u32 s95, s59, s35
    buffer_load_dwordx4 v6, s[40:43], s95 offen lds
    buffer_load_dwordx4 v7, s[40:43], s95 offen offset:2048 lds
    s_waitcnt lgkmcnt(0)
    v_mfma_f32_32x32x16_bf16 v[96:111], v[80:83], v[84:87], v[96:111]
    v_mfma_f32_32x32x16_bf16 v[112:127], v[80:83], v[88:91], v[112:127]
    ds_read_b128 v[80:83], v38 offset:24576
    ds_read_b128 v[84:87], v34 offset:24576
    ds_read_b128 v[88:91], v34 offset:28672
    s_add_u32 m0, s52, 98304
    s_add_u32 s95, s95, 65536
    buffer_load_dwordx4 v6, s[40:43], s95 offen lds
    buffer_load_dwordx4 v7, s[40:43], s95 offen offset:2048 lds
    s_add_u32 s35, s35, 128
    s_and_b32 s35, s35, 1023
    s_waitcnt lgkmcnt(0)
    v_mfma_f32_32x32x16_bf16 v[96:111], v[80:83], v[84:87], v[96:111]
    v_mfma_f32_32x32x16_bf16 v[112:127], v[80:83], v[88:91], v[112:127]
    ds_read_b128 v[80:83], v39 offset:24576
    ds_read_b128 v[84:87], v35 offset:24576
    ds_read_b128 v[88:91], v35 offset:28672
    global_load_dwordx4 v[48:51], v160, s[74:75]
    global_load_dwordx4 v[52:55], v160, s[76:77]
    global_load_ushort v56, v161, s[84:85]
    global_load_ushort v57, v161, s[84:85] offset:1024
    global_load_ushort v58, v161, s[84:85] offset:2048
    global_load_ushort v59, v161, s[84:85] offset:3072
    v_lshlrev_b32 v25, 21, v1
    v_writelane_b32 v25, s94, 3
    s_mov_b64 exec, 8
    buffer_load_dword v162, v25, s[12:15], 0 offen sc1
    s_mov_b64 exec, -1
    global_load_dwordx2 v[160:161], v156, s[80:81]
    s_waitcnt lgkmcnt(0)
    s_waitcnt vmcnt(14)
    s_mov_b64 exec, 1
    ds_add_u32 v146, v147 offset:8
    ds_add_u32 v146, v147 offset:44
    s_mov_b64 exec, -1
    v_mfma_f32_32x32x16_bf16 v[96:111], v[80:83], v[84:87], v[96:111]
    v_mfma_f32_32x32x16_bf16 v[112:127], v[80:83], v[88:91], v[112:127]
    s_mov_b32 s47, 0
L_hb5:
    ds_read_b32 v25, v146 offset:44
    s_add_u32 s47, s47, 1
    s_cmp_gt_u32 s47, 2097152
    s_cbranch_scc1 L_hd6
    s_waitcnt lgkmcnt(0)
    v_cmp_gt_u32 vcc, 8, v25
    s_nop 1
    s_cbranch_vccz L_hd6
    s_branch L_hb5
L_hd6:
    ds_read_b128 v[80:83], v36 offset:49152
    ds_read_b128 v[84:87], v32 offset:49152
    ds_read_b128 v[88:91], v32 offset:53248
    s_add_u32 m0, s52, 106496
    s_add_u32 s95, s60, s35
    buffer_load_dwordx4 v2, s[36:39], s95 offen lds
    buffer_load_dwordx4 v3, s[36:39], s95 offen offset:2048 lds
    s_waitcnt lgkmcnt(0)
    v_mfma_f32_32x32x16_bf16 v[96:111], v[80:83], v[84:87], v[96:111]
    v_mfma_f32_32x32x16_bf16 v[112:127], v[80:83], v[88:91], v[112:127]
    ds_read_b128 v[80:83], v37 offset:49152
    ds_read_b128 v[84:87], v33 offset:49152
    ds_read_b128 v[88:91], v33 offset:53248
    s_add_u32 m0, s52, 114688
    s_add_u32 s95, s59, s35
    buffer_load_dwordx4 v6, s[40:43], s95 offen lds
    buffer_load_dwordx4 v7, s[40:43], s95 offen offset:2048 lds
    s_waitcnt lgkmcnt(0)
    v_mfma_f32_32x32x16_bf16 v[96:111], v[80:83], v[84:87], v[96:111]
    v_mfma_f32_32x32x16_bf16 v[112:127], v[80:83], v[88:91], v[112:127]
    ds_read_b128 v[80:83], v38 offset:49152
    ds_read_b128 v[84:87], v34 offset:49152
    ds_read_b128 v[88:91], v34 offset:53248
    s_add_u32 m0, s52, 122880
    s_add_u32 s95, s95, 65536
    buffer_load_dwordx4 v6, s[40:43], s95 offen lds
    buffer_load_dwordx4 v7, s[40:43], s95 offen offset:2048 lds
    s_add_u32 s35, s35, 128
    s_and_b32 s35, s35, 1023
    s_waitcnt lgkmcnt(0)
    v_mfma_f32_32x32x16_bf16 v[96:111], v[80:83], v[84:87], v[96:111]
    v_mfma_f32_32x32x16_bf16 v[112:127], v[80:83], v[88:91], v[112:127]
    ds_read_b128 v[80:83], v39 offset:49152
    ds_read_b128 v[84:87], v35 offset:49152
    ds_read_b128 v[88:91], v35 offset:53248
    s_waitcnt lgkmcnt(0)
    s_waitcnt vmcnt(14)
    s_mov_b64 exec, 1
    ds_add_u32 v146, v147 offset:44
    s_mov_b64 exec, -1
    v_mfma_f32_32x32x16_bf16 v[96:111], v[80:83], v[84:87], v[96:111]
    v_mfma_f32_32x32x16_bf16 v[112:127], v[80:83], v[88:91], v[112:127]
    s_add_u32 s30, s16, 3
    s_and_b32 s30, s30, 7
    s_lshl_b32 s31, s30, 3
    s_mov_b32 s47, 0
L_rb7:
    s_lshr_b64 s[24:25], s[62:63], s31
    s_and_b32 s24, s24, 0xff
    s_cmp_eq_u32 s24, 0xff
    s_cbranch_scc1 L_rb7g
    buffer_load_dword v26, v165, s[12:15], s50 offen sc1
    s_add_u32 s47, s47, 1
    s_cmp_gt_u32 s47, 2097152
    s_cbranch_scc1 L_rb7g
    s_waitcnt vmcnt(0)
    v_cmp_eq_u32 s[62:63], s20, v26
    s_nop 1
    s_branch L_rb7
L_rb7g:
    s_lshl_b32 s30, s30, 14
    s_add_u32 m0, s51, 49152
    s_add_u32 s30, s30, s61
    buffer_load_dwordx4 v144, s[12:15], s30 offen offset:0 sc1 lds
    buffer_load_dwordx4 v144, s[12:15], s30 offen offset:1024 sc1 lds
    buffer_load_dwordx4 v144, s[12:15], s30 offen offset:2048 sc1 lds
    buffer_load_dwordx4 v144, s[12:15], s30 offen offset:3072 sc1 lds
    s_mov_b32 s47, 0
L_hb8:
    ds_read_b32 v25, v146 offset:44
    s_add_u32 s47, s47, 1
    s_cmp_gt_u32 s47, 2097152
    s_cbranch_scc1 L_hd9
    s_waitcnt lgkmcnt(0)
    v_cmp_gt_u32 vcc, 12, v25
    s_nop 1
    s_cbranch_vccz L_hd9
    s_branch L_hb8
L_hd9:
    ds_read_b128 v[80:83], v36 offset:0
    ds_read_b128 v[84:87], v32 offset:0
    ds_read_b128 v[88:91], v32 offset:4096
    s_add_u32 m0, s52, 131072
    s_add_u32 s95, s60, s35
    buffer_load_dwordx4 v2, s[36:39], s95 offen lds
    buffer_load_dwordx4 v3, s[36:39], s95 offen offset:2048 lds
    s_waitcnt lgkmcnt(0)
    v_mfma_f32_32x32x16_bf16 v[96:111], v[80:83], v[84:87], v[96:111]
    v_mfma_f32_32x32x16_bf16 v[112:127], v[80:83], v[88:91], v[112:127]
    ds_read_b128 v[80:83], v37 offset:0
    ds_read_b128 v[84:87], v33 offset:0
    ds_read_b128 v[88:91], v33 offset:4096
    s_add_u32 m0, s52, 139264
    s_add_u32 s95, s59, s35
    buffer_load_dwordx4 v6, s[40:43], s95 offen lds
    buffer_load_dwordx4 v7, s[40:43], s95 offen offset:2048 lds
    s_waitcnt lgkmcnt(0)
    v_mfma_f32_32x32x16_bf16 v[96:111], v[80:83], v[84:87], v[96:111]
    v_mfma_f32_32x32x16_bf16 v[112:127], v[80:83], v[88:91], v[112:127]
    ds_read_b128 v[80:83], v38 offset:0
    ds_read_b128 v[84:87], v34 offset:0
    ds_read_b128 v[88:91], v34 offset:4096
    s_add_u32 m0, s52, 147456
    s_add_u32 s95, s95, 65536
    buffer_load_dwordx4 v6, s[40:43], s95 offen lds
    buffer_load_dwordx4 v7, s[40:43], s95 offen offset:2048 lds
    s_add_u32 s35, s35, 128
    s_and_b32 s35, s35, 1023
    s_waitcnt lgkmcnt(0)
    v_mfma_f32_32x32x16_bf16 v[96:111], v[80:83], v[84:87], v[96:111]
    v_mfma_f32_32x32x16_bf16 v[112:127], v[80:83], v[88:91], v[112:127]
    ds_read_b128 v[80:83], v39 offset:0
    ds_read_b128 v[84:87], v35 offset:0
    ds_read_b128 v[88:91], v35 offset:4096
    s_waitcnt lgkmcnt(0)
    s_waitcnt vmcnt(10)
    s_mov_b64 exec, 1
    ds_add_u32 v146, v147 offset:44
    s_mov_b64 exec, -1
    v_mfma_f32_32x32x16_bf16 v[96:111], v[80:83], v[84:87], v[96:111]
    v_mfma_f32_32x32x16_bf16 v[112:127], v[80:83], v[88:91], v[112:127]
    s_waitcnt vmcnt(18)
    v_lshlrev_b32 v25, 16, v48
    v_lshlrev_b32 v26, 16, v52
    v_mul_f32 v128, v128, v25
    v_fmac_f32 v128, v136, v26
    v_and_b32 v25, 0xffff0000, v48
    v_and_b32 v26, 0xffff0000, v52
    v_mul_f32 v129, v129, v25
    v_fmac_f32 v129, v137, v26
    v_lshlrev_b32 v25, 16, v49
    v_lshlrev_b32 v26, 16, v53
    v_mul_f32 v130, v130, v25
    v_fmac_f32 v130, v138, v26
    v_and_b32 v25, 0xffff0000, v49
    v_and_b32 v26, 0xffff0000, v53
    v_mul_f32 v131, v131, v25
    v_fmac_f32 v131, v139, v26
    v_lshlrev_b32 v25, 16, v50
    v_lshlrev_b32 v26, 16, v54
    v_mul_f32 v132, v132, v25
    v_fmac_f32 v132, v140, v26
    v_and_b32 v25, 0xffff0000, v50
    v_and_b32 v26, 0xffff0000, v54
    v_mul_f32 v133, v133, v25
    v_fmac_f32 v133, v141, v26
    v_lshlrev_b32 v25, 16, v51
    v_lshlrev_b32 v26, 16, v55
    v_mul_f32 v134, v134, v25
    v_fmac_f32 v134, v142, v26
    v_and_b32 v25, 0xffff0000, v51
    v_and_b32 v26, 0xffff0000, v55
    v_mul_f32 v135, v135, v25
    v_fmac_f32 v135, v143, v26
    v_cvt_pk_bf16_f32 v48, v128, v129
    v_cvt_pk_bf16_f32 v49, v130, v131
    v_cvt_pk_bf16_f32 v50, v132, v133
    v_cvt_pk_bf16_f32 v51, v134, v135
    v_lshl_or_b32 v56, v57, 16, v56
    v_lshl_or_b32 v57, v59, 16, v58
    s_lshl_b32 s23, s26, 16
    s_lshl_b32 s24, s27, 2
    s_add_u32 s24, s24, s48
    s_lshl_b32 s24, s24, 10
    s_add_u32 s23, s23, s24
    s_add_u32 s23, s23, 1048576
    s_lshl_b32 s24, s26, 5
    s_add_u32 s24, s24, s29
    s_lshl_b32 s24, s24, 10
    s_lshl_b32 s25, s28, 3
    s_add_u32 s24, s24, s25
    s_add_u32 s24, s24, 524288
    buffer_store_dwordx4 v[48:51], v144, s[12:15], s23 offen sc1
    buffer_store_dwordx2 v[56:57], v144, s[12:15], s24 offen sc1
    s_mov_b32 s47, 0
L_hb10:
    ds_read_b32 v25, v146 offset:44
    s_add_u32 s47, s47, 1
    s_cmp_gt_u32 s47, 2097152
    s_cbranch_scc1 L_hd11
    s_waitcnt lgkmcnt(0)
    v_cmp_gt_u32 vcc, 16, v25
    s_nop 1
    s_cbranch_vccz L_hd11
    s_branch L_hb10
L_hd11:
    ds_read_b128 v[80:83], v36 offset:24576
    ds_read_b128 v[84:87], v32 offset:24576
    ds_read_b128 v[88:91], v32 offset:28672
    s_add_u32 m0, s52, 81920
    s_add_u32 s95, s60, s35
    buffer_load_dwordx4 v2, s[36:39], s95 offen lds
    buffer_load_dwordx4 v3, s[36:39], s95 offen offset:2048 lds
    s_waitcnt lgkmcnt(0)
    v_mfma_f32_32x32x16_bf16 v[96:111], v[80:83], v[84:87], v[96:111]
    v_mfma_f32_32x32x16_bf16 v[112:127], v[80:83], v[88:91], v[112:127]
    ds_read_b128 v[80:83], v37 offset:24576
    ds_read_b128 v[84:87], v33 offset:24576
    ds_read_b128 v[88:91], v33 offset:28672
    s_add_u32 m0, s52, 90112
    s_add_u32 s95, s59, s35
    buffer_load_dwordx4 v6, s[40:43], s95 offen lds
    buffer_load_dwordx4 v7, s[40:43], s95 offen offset:2048 lds
    s_waitcnt lgkmcnt(0)
    v_mfma_f32_32x32x16_bf16 v[96:111], v[80:83], v[84:87], v[96:111]
    v_mfma_f32_32x32x16_bf16 v[112:127], v[80:83], v[88:91], v[112:127]
    ds_read_b128 v[80:83], v38 offset:24576
    ds_read_b128 v[84:87], v34 offset:24576
    ds_read_b128 v[88:91], v34 offset:28672
    s_add_u32 m0, s52, 98304
    s_add_u32 s95, s95, 65536
    buffer_load_dwordx4 v6, s[40:43], s95 offen lds
    buffer_load_dwordx4 v7, s[40:43], s95 offen offset:2048 lds
    s_add_u32 s35, s35, 128
    s_and_b32 s35, s35, 1023
    s_waitcnt lgkmcnt(0)
    v_mfma_f32_32x32x16_bf16 v[96:111], v[80:83], v[84:87], v[96:111]
    v_mfma_f32_32x32x16_bf16 v[112:127], v[80:83], v[88:91], v[112:127]
    ds_read_b128 v[80:83], v39 offset:24576
    ds_read_b128 v[84:87], v35 offset:24576
    ds_read_b128 v[88:91], v35 offset:28672
    s_waitcnt lgkmcnt(0)
    s_waitcnt vmcnt(8)
    s_mov_b64 exec, 1
    ds_add_u32 v146, v147 offset:12
    ds_add_u32 v146, v147 offset:44
    s_mov_b64 exec, -1
    v_mfma_f32_32x32x16_bf16 v[96:111], v[80:83], v[84:87], v[96:111]
    v_mfma_f32_32x32x16_bf16 v[112:127], v[80:83], v[88:91], v[112:127]
    s_mov_b32 s47, 0
L_hb12:
    ds_read_b32 v25, v146 offset:44
    s_add_u32 s47, s47, 1
    s_cmp_gt_u32 s47, 2097152
    s_cbranch_scc1 L_hd13
    s_waitcnt lgkmcnt(0)
    v_cmp_gt_u32 vcc, 20, v25
    s_nop 1
    s_cbranch_vccz L_hd13
    s_branch L_hb12
L_hd13:
    ds_read_b128 v[80:83], v36 offset:49152
    ds_read_b128 v[84:87], v32 offset:49152
    ds_read_b128 v[88:91], v32 offset:53248
    s_add_u32 m0, s52, 106496
    s_add_u32 s95, s60, s35
    buffer_load_dwordx4 v2, s[36:39], s95 offen lds
    buffer_load_dwordx4 v3, s[36:39], s95 offen offset:2048 lds
    s_waitcnt lgkmcnt(0)
    v_mfma_f32_32x32x16_bf16 v[96:111], v[80:83], v[84:87], v[96:111]
    v_mfma_f32_32x32x16_bf16 v[112:127], v[80:83], v[88:91], v[112:127]
    ds_read_b128 v[80:83], v37 offset:49152
    ds_read_b128 v[84:87], v33 offset:49152
    ds_read_b128 v[88:91], v33 offset:53248
    s_add_u32 m0, s52, 114688
    s_add_u32 s95, s59, s35
    buffer_load_dwordx4 v6, s[40:43], s95 offen lds
    buffer_load_dwordx4 v7, s[40:43], s95 offen offset:2048 lds
    s_waitcnt lgkmcnt(0)
    v_mfma_f32_32x32x16_bf16 v[96:111], v[80:83], v[84:87], v[96:111]
    v_mfma_f32_32x32x16_bf16 v[112:127], v[80:83], v[88:91], v[112:127]
    ds_read_b128 v[80:83], v38 offset:49152
    ds_read_b128 v[84:87], v34 offset:49152
    ds_read_b128 v[88:91], v34 offset:53248
    s_add_u32 m0, s52, 122880
    s_add_u32 s95, s95, 65536
    buffer_load_dwordx4 v6, s[40:43], s95 offen lds
    buffer_load_dwordx4 v7, s[40:43], s95 offen offset:2048 lds
    s_add_u32 s35, s35, 128
    s_and_b32 s35, s35, 1023
    s_waitcnt lgkmcnt(0)
    v_mfma_f32_32x32x16_bf16 v[96:111], v[80:83], v[84:87], v[96:111]
    v_mfma_f32_32x32x16_bf16 v[112:127], v[80:83], v[88:91], v[112:127]
    ds_read_b128 v[80:83], v39 offset:49152
    ds_read_b128 v[84:87], v35 offset:49152
    ds_read_b128 v[88:91], v35 offset:53248
    s_waitcnt lgkmcnt(0)
    s_waitcnt vmcnt(6)
    s_mov_b64 exec, 1
    ds_add_u32 v146, v147 offset:44
    s_mov_b64 exec, -1
    v_mfma_f32_32x32x16_bf16 v[96:111], v[80:83], v[84:87], v[96:111]
    v_mfma_f32_32x32x16_bf16 v[112:127], v[80:83], v[88:91], v[112:127]
    s_add_u32 s30, s16, 4
    s_and_b32 s30, s30, 7
    s_lshl_b32 s31, s30, 3
    s_mov_b32 s47, 0
L_rb14:
    s_lshr_b64 s[24:25], s[62:63], s31
    s_and_b32 s24, s24, 0xff
    s_cmp_eq_u32 s24, 0xff
    s_cbranch_scc1 L_rb14g
    buffer_load_dword v26, v165, s[12:15], s50 offen sc1
    s_add_u32 s47, s47, 1
    s_cmp_gt_u32 s47, 2097152
    s_cbranch_scc1 L_rb14g
    s_waitcnt vmcnt(0)
    v_cmp_eq_u32 s[62:63], s20, v26
    s_nop 1
    s_branch L_rb14
L_rb14g:
    s_lshl_b32 s30, s30, 14
    s_add_u32 m0, s51, 65536
    s_add_u32 s30, s30, s61
    buffer_load_dwordx4 v144, s[12:15], s30 offen offset:0 sc1 lds
    buffer_load_dwordx4 v144, s[12:15], s30 offen offset:1024 sc1 lds
    buffer_load_dwordx4 v144, s[12:15], s30 offen offset:2048 sc1 lds
    buffer_load_dwordx4 v144, s[12:15], s30 offen offset:3072 sc1 lds
    s_mov_b32 s47, 0
L_hb15:
    ds_read_b32 v25, v146 offset:44
    s_add_u32 s47, s47, 1
    s_cmp_gt_u32 s47, 2097152
    s_cbranch_scc1 L_hd16
    s_waitcnt lgkmcnt(0)
    v_cmp_gt_u32 vcc, 24, v25
    s_nop 1
    s_cbranch_vccz L_hd16
    s_branch L_hb15
L_hd16:
    s_lshl_b32 s23, s16, 5
    s_add_u32 s23, s23, s17
    s_lshl_b32 s23, s23, 4
    s_add_u32 s23, s23, 32768
    v_mov_b32 v28, s20
    s_cmp_eq_u32 s48, 0
    s_mov_b64 exec, 1
    s_cbranch_scc0 L_ff17
    buffer_store_dword v28, off, s[12:15], s23 sc1
    s_branch L_fd18
L_ff17:
    buffer_load_dword v162, off, s[12:15], s94 sc1
L_fd18:
    s_mov_b64 exec, -1
    ds_read_b128 v[80:83], v36 offset:0
    ds_read_b128 v[84:87], v32 offset:0
    ds_read_b128 v[88:91], v32 offset:4096
    s_add_u32 m0, s52, 131072
    s_add_u32 s95, s60, s35
    buffer_load_dwordx4 v2, s[36:39], s95 offen lds
    buffer_load_dwordx4 v3, s[36:39], s95 offen offset:2048 lds
    s_waitcnt lgkmcnt(0)
    v_mfma_f32_32x32x16_bf16 v[96:111], v[80:83], v[84:87], v[96:111]
    v_mfma_f32_32x32x16_bf16 v[112:127], v[80:83], v[88:91], v[112:127]
    ds_read_b128 v[80:83], v37 offset:0
    ds_read_b128 v[84:87], v33 offset:0
    ds_read_b128 v[88:91], v33 offset:4096
    s_add_u32 m0, s52, 139264
    s_add_u32 s95, s59, s35
    buffer_load_dwordx4 v6, s[40:43], s95 offen lds
    buffer_load_dwordx4 v7, s[40:43], s95 offen offset:2048 lds
    s_waitcnt lgkmcnt(0)
    v_mfma_f32_32x32x16_bf16 v[96:111], v[80:83], v[84:87], v[96:111]
    v_mfma_f32_32x32x16_bf16 v[112:127], v[80:83], v[88:91], v[112:127]
    ds_read_b128 v[80:83], v38 offset:0
    ds_read_b128 v[84:87], v34 offset:0
    ds_read_b128 v[88:91], v34 offset:4096
    s_add_u32 m0, s52, 147456
    s_add_u32 s95, s95, 65536
    buffer_load_dwordx4 v6, s[40:43], s95 offen lds
    buffer_load_dwordx4 v7, s[40:43], s95 offen offset:2048 lds
    s_add_u32 s35, s35, 128
    s_and_b32 s35, s35, 1023
    s_waitcnt lgkmcnt(0)
    v_mfma_f32_32x32x16_bf16 v[96:111], v[80:83], v[84:87], v[96:111]
    v_mfma_f32_32x32x16_bf16 v[112:127], v[80:83], v[88:91], v[112:127]
    ds_read_b128 v[80:83], v39 offset:0
    ds_read_b128 v[84:87], v35 offset:0
    ds_read_b128 v[88:91], v35 offset:4096
    s_waitcnt lgkmcnt(0)
    s_waitcnt vmcnt(11)
    s_mov_b64 exec, 1
    ds_add_u32 v146, v147 offset:44
    s_mov_b64 exec, -1
    v_mfma_f32_32x32x16_bf16 v[96:111], v[80:83], v[84:87], v[96:111]
    v_mfma_f32_32x32x16_bf16 v[112:127], v[80:83], v[88:91], v[112:127]
    s_mov_b32 s47, 0
L_hb19:
    ds_read_b32 v25, v146 offset:44
    s_add_u32 s47, s47, 1
    s_cmp_gt_u32 s47, 2097152
    s_cbranch_scc1 L_hd20
    s_waitcnt lgkmcnt(0)
    v_cmp_gt_u32 vcc, 28, v25
    s_nop 1
    s_cbranch_vccz L_hd20
    s_branch L_hb19
L_hd20:
    ds_read_b128 v[80:83], v36 offset:24576
    ds_read_b128 v[84:87], v32 offset:24576
    ds_read_b128 v[88:91], v32 offset:28672
    s_waitcnt lgkmcnt(0)
    v_mfma_f32_32x32x16_bf16 v[96:111], v[80:83], v[84:87], v[96:111]
    v_mfma_f32_32x32x16_bf16 v[112:127], v[80:83], v[88:91], v[112:127]
    ds_read_b128 v[80:83], v37 offset:24576
    ds_read_b128 v[84:87], v33 offset:24576
    ds_read_b128 v[88:91], v33 offset:28672
    s_waitcnt lgkmcnt(0)
    v_mfma_f32_32x32x16_bf16 v[96:111], v[80:83], v[84:87], v[96:111]
    v_mfma_f32_32x32x16_bf16 v[112:127], v[80:83], v[88:91], v[112:127]
    ds_read_b128 v[80:83], v38 offset:24576
    ds_read_b128 v[84:87], v34 offset:24576
    ds_read_b128 v[88:91], v34 offset:28672
    s_waitcnt lgkmcnt(0)
    v_mfma_f32_32x32x16_bf16 v[96:111], v[80:83], v[84:87], v[96:111]
    v_mfma_f32_32x32x16_bf16 v[112:127], v[80:83], v[88:91], v[112:127]
    ds_read_b128 v[80:83], v39 offset:24576
    ds_read_b128 v[84:87], v35 offset:24576
    ds_read_b128 v[88:91], v35 offset:28672
    s_waitcnt lgkmcnt(0)
    s_waitcnt vmcnt(0)
    s_mov_b64 exec, 1
    ds_add_u32 v146, v147 offset:16
    ds_add_u32 v146, v147 offset:44
    s_mov_b64 exec, -1
    v_mfma_f32_32x32x16_bf16 v[96:111], v[80:83], v[84:87], v[96:111]
    v_mfma_f32_32x32x16_bf16 v[112:127], v[80:83], v[88:91], v[112:127]
    s_mov_b32 s47, 0
L_hb21:
    ds_read_b32 v25, v146 offset:44
    s_add_u32 s47, s47, 1
    s_cmp_gt_u32 s47, 2097152
    s_cbranch_scc1 L_hd22
    s_waitcnt lgkmcnt(0)
    v_cmp_gt_u32 vcc, 32, v25
    s_nop 1
    s_cbranch_vccz L_hd22
    s_branch L_hb21
L_hd22:
    ds_read_b128 v[80:83], v36 offset:49152
    ds_read_b128 v[84:87], v32 offset:49152
    ds_read_b128 v[88:91], v32 offset:53248
    s_waitcnt lgkmcnt(0)
    v_mfma_f32_32x32x16_bf16 v[96:111], v[80:83], v[84:87], v[96:111]
    v_mfma_f32_32x32x16_bf16 v[112:127], v[80:83], v[88:91], v[112:127]
    ds_read_b128 v[80:83], v37 offset:49152
    ds_read_b128 v[84:87], v33 offset:49152
    ds_read_b128 v[88:91], v33 offset:53248
    s_waitcnt lgkmcnt(0)
    v_mfma_f32_32x32x16_bf16 v[96:111], v[80:83], v[84:87], v[96:111]
    v_mfma_f32_32x32x16_bf16 v[112:127], v[80:83], v[88:91], v[112:127]
    ds_read_b128 v[80:83], v38 offset:49152
    ds_read_b128 v[84:87], v34 offset:49152
    ds_read_b128 v[88:91], v34 offset:53248
    s_waitcnt lgkmcnt(0)
    v_mfma_f32_32x32x16_bf16 v[96:111], v[80:83], v[84:87], v[96:111]
    v_mfma_f32_32x32x16_bf16 v[112:127], v[80:83], v[88:91], v[112:127]
    ds_read_b128 v[80:83], v39 offset:49152
    ds_read_b128 v[84:87], v35 offset:49152
    ds_read_b128 v[88:91], v35 offset:53248
    s_waitcnt lgkmcnt(0)
    v_mfma_f32_32x32x16_bf16 v[96:111], v[80:83], v[84:87], v[96:111]
    v_mfma_f32_32x32x16_bf16 v[112:127], v[80:83], v[88:91], v[112:127]
    s_nop 7
    s_nop 3
    v_pk_fma_f32 v[40:41], v[8:9], v[96:97], v[98:99] op_sel_hi:[0,1,1]
    v_pk_fma_f32 v[42:43], v[8:9], v[112:113], v[114:115] op_sel_hi:[0,1,1]
    v_pk_fma_f32 v[40:41], v[8:9], v[112:113], v[40:41] op_sel:[1,0,0] neg_lo:[1,0,0] neg_hi:[1,0,0]
    v_pk_fma_f32 v[42:43], v[8:9], v[96:97], v[42:43] op_sel:[1,0,0]
    v_pk_fma_f32 v[44:45], v[8:9], v[40:41], v[100:101] op_sel_hi:[0,1,1]
    v_pk_fma_f32 v[46:47], v[8:9], v[42:43], v[116:117] op_sel_hi:[0,1,1]
    v_pk_fma_f32 v[44:45], v[8:9], v[42:43], v[44:45] op_sel:[1,0,0] neg_lo:[1,0,0] neg_hi:[1,0,0]
    v_pk_fma_f32 v[46:47], v[8:9], v[40:41], v[46:47] op_sel:[1,0,0]
    v_pk_fma_f32 v[40:41], v[8:9], v[44:45], v[102:103] op_sel_hi:[0,1,1]
    v_pk_fma_f32 v[42:43], v[8:9], v[46:47], v[118:119] op_sel_hi:[0,1,1]
    v_pk_fma_f32 v[40:41], v[8:9], v[46:47], v[40:41] op_sel:[1,0,0] neg_lo:[1,0,0] neg_hi:[1,0,0]
    v_pk_fma_f32 v[42:43], v[8:9], v[44:45], v[42:43] op_sel:[1,0,0]
    v_pk_fma_f32 v[44:45], v[8:9], v[40:41], v[104:105] op_sel_hi:[0,1,1]
    v_pk_fma_f32 v[46:47], v[8:9], v[42:43], v[120:121] op_sel_hi:[0,1,1]
    v_pk_fma_f32 v[44:45], v[8:9], v[42:43], v[44:45] op_sel:[1,0,0] neg_lo:[1,0,0] neg_hi:[1,0,0]
    v_pk_fma_f32 v[46:47], v[8:9], v[40:41], v[46:47] op_sel:[1,0,0]
    v_pk_fma_f32 v[40:41], v[8:9], v[44:45], v[106:107] op_sel_hi:[0,1,1]
    v_pk_fma_f32 v[42:43], v[8:9], v[46:47], v[122:123] op_sel_hi:[0,1,1]
    v_pk_fma_f32 v[40:41], v[8:9], v[46:47], v[40:41] op_sel:[1,0,0] neg_lo:[1,0,0] neg_hi:[1,0,0]
    v_pk_fma_f32 v[42:43], v[8:9], v[44:45], v[42:43] op_sel:[1,0,0]
    v_pk_fma_f32 v[44:45], v[8:9], v[40:41], v[108:109] op_sel_hi:[0,1,1]
    v_pk_fma_f32 v[46:47], v[8:9], v[42:43], v[124:125] op_sel_hi:[0,1,1]
    v_pk_fma_f32 v[44:45], v[8:9], v[42:43], v[44:45] op_sel:[1,0,0] neg_lo:[1,0,0] neg_hi:[1,0,0]
    v_pk_fma_f32 v[46:47], v[8:9], v[40:41], v[46:47] op_sel:[1,0,0]
    v_pk_fma_f32 v[40:41], v[8:9], v[44:45], v[110:111] op_sel_hi:[0,1,1]
    v_pk_fma_f32 v[42:43], v[8:9], v[46:47], v[126:127] op_sel_hi:[0,1,1]
    v_pk_fma_f32 v[40:41], v[8:9], v[46:47], v[40:41] op_sel:[1,0,0] neg_lo:[1,0,0] neg_hi:[1,0,0]
    v_pk_fma_f32 v[42:43], v[8:9], v[44:45], v[42:43] op_sel:[1,0,0]
    v_fma_f32 v44, v10, v40, v41
    v_fma_f32 v45, v10, v42, v43
    v_fma_f32 v44, -v11, v42, v44
    v_fmac_f32 v45, v11, v40
    v_pk_mov_b32 v[46:47], v[44:45], v[44:45] op_sel:[0,1]
    s_nop 1
    v_permlane32_swap_b32 v44, v46
    v_permlane32_swap_b32 v45, v47
    v_pk_fma_f32 v[46:47], v[12:13], v[44:45], v[46:47] op_sel_hi:[0,1,1]
    v_pk_fma_f32 v[46:47], v[12:13], v[44:45], v[46:47] op_sel:[1,1,0] op_sel_hi:[1,0,1] neg_lo:[1,0,0]
    ds_write_b64 v149, v[46:47]
    s_waitcnt lgkmcnt(0)
    s_mov_b64 exec, 1
    ds_add_u32 v146, v147 offset:40
    s_mov_b64 exec, -1
    s_mov_b32 s47, 0
L_hb23:
    ds_read_b32 v25, v146 offset:40
    s_add_u32 s47, s47, 1
    s_cmp_gt_u32 s47, 2097152
    s_cbranch_scc1 L_hd24
    s_waitcnt lgkmcnt(0)
    v_cmp_gt_u32 vcc, 4, v25
    s_nop 1
    s_cbranch_vccz L_hd24
    s_branch L_hb23
L_hd24:
    ds_read_b64 v[2:3], v148 offset:0
    ds_read_b64 v[4:5], v148 offset:256
    ds_read_b64 v[6:7], v148 offset:512
    ds_read_b64 v[64:65], v148 offset:768
    s_add_u32 s4, s12, 65536
    s_addc_u32 s5, s13, 0
    s_mov_b32 s6, 0x20000
    s_mov_b32 s7, 0x20000
    s_sub_u32 s23, 15, s26
    s_lshl_b32 s23, s23, 13
    s_lshl_b32 s24, s48, 3
    s_lshl_b64 s[24:25], 0xff, s24
    v_mov_b32 v66, s20
    s_waitcnt lgkmcnt(0)
    v_pk_fma_f32 v[60:61], v[14:15], v[2:3], v[4:5] op_sel_hi:[0,1,1]
    v_pk_fma_f32 v[60:61], v[14:15], v[2:3], v[60:61] op_sel:[1,1,0] op_sel_hi:[1,0,1] neg_lo:[1,0,0]
    v_pk_fma_f32 v[62:63], v[14:15], v[60:61], v[6:7] op_sel_hi:[0,1,1]
    v_pk_fma_f32 v[62:63], v[14:15], v[60:61], v[62:63] op_sel:[1,1,0] op_sel_hi:[1,0,1] neg_lo:[1,0,0]
    v_pk_fma_f32 v[64:65], v[14:15], v[62:63], v[64:65] op_sel_hi:[0,1,1]
    v_pk_fma_f32 v[64:65], v[14:15], v[62:63], v[64:65] op_sel:[1,1,0] op_sel_hi:[1,0,1] neg_lo:[1,0,0]
    v_bitop3_b32 v67, v64, v65, v66 bitop3:0x96
    s_mov_b64 exec, s[24:25]
    buffer_store_dwordx4 v[64:67], v150, s[4:7], s23 offen sc1
    s_mov_b64 exec, -1
    s_add_u32 s30, s16, 5
    s_and_b32 s30, s30, 7
    s_lshl_b32 s31, s30, 3
    s_mov_b32 s47, 0
L_rb25:
    s_lshr_b64 s[24:25], s[62:63], s31
    s_and_b32 s24, s24, 0xff
    s_cmp_eq_u32 s24, 0xff
    s_cbranch_scc1 L_rb25g
    buffer_load_dword v26, v165, s[12:15], s50 offen sc1
    s_add_u32 s47, s47, 1
    s_cmp_gt_u32 s47, 2097152
    s_cbranch_scc1 L_rb25g
    s_waitcnt vmcnt(0)
    v_cmp_eq_u32 s[62:63], s20, v26
    s_nop 1
    s_branch L_rb25
L_rb25g:
    s_lshl_b32 s30, s30, 14
    s_add_u32 m0, s51, 81920
    s_add_u32 s30, s30, s61
    buffer_load_dwordx4 v144, s[12:15], s30 offen offset:0 sc1 lds
    buffer_load_dwordx4 v144, s[12:15], s30 offen offset:1024 sc1 lds
    buffer_load_dwordx4 v144, s[12:15], s30 offen offset:2048 sc1 lds
    buffer_load_dwordx4 v144, s[12:15], s30 offen offset:3072 sc1 lds
    s_add_u32 s30, s16, 6
    s_and_b32 s30, s30, 7
    s_lshl_b32 s31, s30, 3
    s_mov_b32 s47, 0
L_rb26:
    s_lshr_b64 s[24:25], s[62:63], s31
    s_and_b32 s24, s24, 0xff
    s_cmp_eq_u32 s24, 0xff
    s_cbranch_scc1 L_rb26g
    buffer_load_dword v26, v165, s[12:15], s50 offen sc1
    s_add_u32 s47, s47, 1
    s_cmp_gt_u32 s47, 2097152
    s_cbranch_scc1 L_rb26g
    s_waitcnt vmcnt(0)
    v_cmp_eq_u32 s[62:63], s20, v26
    s_nop 1
    s_branch L_rb26
L_rb26g:
    s_lshl_b32 s30, s30, 14
    s_add_u32 m0, s51, 98304
    s_add_u32 s30, s30, s61
    buffer_load_dwordx4 v144, s[12:15], s30 offen offset:0 sc1 lds
    buffer_load_dwordx4 v144, s[12:15], s30 offen offset:1024 sc1 lds
    buffer_load_dwordx4 v144, s[12:15], s30 offen offset:2048 sc1 lds
    buffer_load_dwordx4 v144, s[12:15], s30 offen offset:3072 sc1 lds
    s_lshl_b32 s28, s19, 9
    s_add_u32 s28, s28, 32768
    buffer_load_dword v31, v145, s[12:15], s28 offen sc1
    s_waitcnt vmcnt(0)
    s_mov_b64 exec, 1
    ds_add_u32 v146, v147 offset:20
    ds_add_u32 v146, v147 offset:24
    s_mov_b64 exec, -1
    v_cmp_ne_u32 vcc, s20, v31
    s_nop 1
    s_cbranch_vccz L_FPK
    s_mov_b32 s47, 0
L_poll27:
    buffer_load_dword v26, v145, s[12:15], s28 offen sc1
    s_add_u32 s47, s47, 1
    s_cmp_gt_u32 s47, 2097152
    s_cbranch_scc1 L_pd28
    s_waitcnt vmcnt(0)
    v_cmp_ne_u32 vcc, s20, v26
    s_nop 1
    s_cbranch_vccnz L_poll27
L_pd28:
L_FPK:
    s_add_u32 s30, s16, 7
    s_and_b32 s30, s30, 7
    s_lshl_b32 s31, s30, 3
    s_mov_b32 s47, 0
L_rb29:
    s_lshr_b64 s[24:25], s[62:63], s31
    s_and_b32 s24, s24, 0xff
    s_cmp_eq_u32 s24, 0xff
    s_cbranch_scc1 L_rb29g
    buffer_load_dword v26, v165, s[12:15], s50 offen sc1
    s_add_u32 s47, s47, 1
    s_cmp_gt_u32 s47, 2097152
    s_cbranch_scc1 L_rb29g
    s_waitcnt vmcnt(0)
    v_cmp_eq_u32 s[62:63], s20, v26
    s_nop 1
    s_branch L_rb29
L_rb29g:
    s_lshl_b32 s30, s30, 14
    s_add_u32 m0, s51, 114688
    s_add_u32 s30, s30, s61
    buffer_load_dwordx4 v144, s[12:15], s30 offen offset:0 sc1 lds
    buffer_load_dwordx4 v144, s[12:15], s30 offen offset:1024 sc1 lds
    buffer_load_dwordx4 v144, s[12:15], s30 offen offset:2048 sc1 lds
    buffer_load_dwordx4 v144, s[12:15], s30 offen offset:3072 sc1 lds
    v_lshlrev_b32 v25, 7, v1
    s_lshl_b32 s23, s19, 2
    s_add_u32 s23, s23, s18
    s_lshl_b32 s23, s23, 2
    s_add_u32 s23, s23, s48
    s_lshl_b32 s24, s23, 13
    s_add_u32 s24, s24, 1048576
    buffer_load_dword v164, v25, s[12:15], s24 offen sc1
    s_mov_b32 s23, 0
    buffer_load_dwordx4 v[48:51], v151, s[4:7], s23 offen sc1
    s_mov_b32 s23, 8192
    buffer_load_dwordx4 v[52:55], v151, s[4:7], s23 offen sc1
    s_mov_b32 s23, 16384
    buffer_load_dwordx4 v[56:59], v151, s[4:7], s23 offen sc1
    s_mov_b32 s23, 24576
    buffer_load_dwordx4 v[60:63], v151, s[4:7], s23 offen sc1
    s_mov_b32 s23, 32768
    buffer_load_dwordx4 v[64:67], v151, s[4:7], s23 offen sc1
    s_mov_b32 s23, 40960
    buffer_load_dwordx4 v[68:71], v151, s[4:7], s23 offen sc1
    s_mov_b32 s23, 49152
    buffer_load_dwordx4 v[72:75], v151, s[4:7], s23 offen sc1
    s_mov_b32 s23, 57344
    buffer_load_dwordx4 v[76:79], v151, s[4:7], s23 offen sc1
    s_waitcnt vmcnt(0)
    s_mov_b64 exec, 1
    ds_add_u32 v146, v147 offset:28
    s_mov_b64 exec, -1
    s_mov_b32 s47, 0
L_EC:
    s_mov_b64 s[30:31], -1
    v_bitop3_b32 v50, v48, v49, v51 bitop3:0x96
    v_cmp_eq_u32 vcc, s20, v50
    s_cmp_le_u32 s26, 0
    s_cselect_b32 s28, -1, 0
    s_cmp_le_u32 s26, 8
    s_cselect_b32 s29, -1, 0
    s_or_b64 vcc, vcc, s[28:29]
    s_and_b64 s[30:31], s[30:31], vcc
    v_bitop3_b32 v54, v52, v53, v55 bitop3:0x96
    v_cmp_eq_u32 vcc, s20, v54
    s_cmp_le_u32 s26, 1
    s_cselect_b32 s28, -1, 0
    s_cmp_le_u32 s26, 9
    s_cselect_b32 s29, -1, 0
    s_or_b64 vcc, vcc, s[28:29]
    s_and_b64 s[30:31], s[30:31], vcc
    v_bitop3_b32 v58, v56, v57, v59 bitop3:0x96
    v_cmp_eq_u32 vcc, s20, v58
    s_cmp_le_u32 s26, 2
    s_cselect_b32 s28, -1, 0
    s_cmp_le_u32 s26, 10
    s_cselect_b32 s29, -1, 0
    s_or_b64 vcc, vcc, s[28:29]
    s_and_b64 s[30:31], s[30:31], vcc
    v_bitop3_b32 v62, v60, v61, v63 bitop3:0x96
    v_cmp_eq_u32 vcc, s20, v62
    s_cmp_le_u32 s26, 3
    s_cselect_b32 s28, -1, 0
    s_cmp_le_u32 s26, 11
    s_cselect_b32 s29, -1, 0
    s_or_b64 vcc, vcc, s[28:29]
    s_and_b64 s[30:31], s[30:31], vcc
    v_bitop3_b32 v66, v64, v65, v67 bitop3:0x96
    v_cmp_eq_u32 vcc, s20, v66
    s_cmp_le_u32 s26, 4
    s_cselect_b32 s28, -1, 0
    s_cmp_le_u32 s26, 12
    s_cselect_b32 s29, -1, 0
    s_or_b64 vcc, vcc, s[28:29]
    s_and_b64 s[30:31], s[30:31], vcc
    v_bitop3_b32 v70, v68, v69, v71 bitop3:0x96
    v_cmp_eq_u32 vcc, s20, v70
    s_cmp_le_u32 s26, 5
    s_cselect_b32 s28, -1, 0
    s_cmp_le_u32 s26, 13
    s_cselect_b32 s29, -1, 0
    s_or_b64 vcc, vcc, s[28:29]
    s_and_b64 s[30:31], s[30:31], vcc
    v_bitop3_b32 v74, v72, v73, v75 bitop3:0x96
    v_cmp_eq_u32 vcc, s20, v74
    s_cmp_le_u32 s26, 6
    s_cselect_b32 s28, -1, 0
    s_cmp_le_u32 s26, 14
    s_cselect_b32 s29, -1, 0
    s_or_b64 vcc, vcc, s[28:29]
    s_and_b64 s[30:31], s[30:31], vcc
    v_bitop3_b32 v78, v76, v77, v79 bitop3:0x96
    v_cmp_eq_u32 vcc, s20, v78
    s_cmp_le_u32 s26, 7
    s_cselect_b32 s28, -1, 0
    s_cmp_le_u32 s26, 15
    s_cselect_b32 s29, -1, 0
    s_or_b64 vcc, vcc, s[28:29]
    s_and_b64 s[30:31], s[30:31], vcc
    s_cmp_eq_u64 s[30:31], -1
    s_cbranch_scc1 L_EG
    s_add_u32 s47, s47, 1
    s_cmp_gt_u32 s47, 2097152
    s_cbranch_scc1 L_EG
    s_mov_b32 s23, 0
    buffer_load_dwordx4 v[48:51], v151, s[4:7], s23 offen sc1
    s_mov_b32 s23, 8192
    buffer_load_dwordx4 v[52:55], v151, s[4:7], s23 offen sc1
    s_mov_b32 s23, 16384
    buffer_load_dwordx4 v[56:59], v151, s[4:7], s23 offen sc1
    s_mov_b32 s23, 24576
    buffer_load_dwordx4 v[60:63], v151, s[4:7], s23 offen sc1
    s_mov_b32 s23, 32768
    buffer_load_dwordx4 v[64:67], v151, s[4:7], s23 offen sc1
    s_mov_b32 s23, 40960
    buffer_load_dwordx4 v[68:71], v151, s[4:7], s23 offen sc1
    s_mov_b32 s23, 49152
    buffer_load_dwordx4 v[72:75], v151, s[4:7], s23 offen sc1
    s_mov_b32 s23, 57344
    buffer_load_dwordx4 v[76:79], v151, s[4:7], s23 offen sc1
    s_waitcnt vmcnt(0)
    s_branch L_EC
L_EG:
    v_pk_fma_f32 v[72:73], v[16:17], v[76:77], v[72:73] op_sel_hi:[0,1,1]
    v_pk_fma_f32 v[72:73], v[16:17], v[76:77], v[72:73] op_sel:[1,1,0] op_sel_hi:[1,0,1] neg_lo:[1,0,0]
    v_pk_fma_f32 v[68:69], v[16:17], v[72:73], v[68:69] op_sel_hi:[0,1,1]
    v_pk_fma_f32 v[68:69], v[16:17], v[72:73], v[68:69] op_sel:[1,1,0] op_sel_hi:[1,0,1] neg_lo:[1,0,0]
    v_pk_fma_f32 v[64:65], v[16:17], v[68:69], v[64:65] op_sel_hi:[0,1,1]
    v_pk_fma_f32 v[64:65], v[16:17], v[68:69], v[64:65] op_sel:[1,1,0] op_sel_hi:[1,0,1] neg_lo:[1,0,0]
    v_pk_fma_f32 v[60:61], v[16:17], v[64:65], v[60:61] op_sel_hi:[0,1,1]
    v_pk_fma_f32 v[60:61], v[16:17], v[64:65], v[60:61] op_sel:[1,1,0] op_sel_hi:[1,0,1] neg_lo:[1,0,0]
    v_pk_fma_f32 v[56:57], v[16:17], v[60:61], v[56:57] op_sel_hi:[0,1,1]
    v_pk_fma_f32 v[56:57], v[16:17], v[60:61], v[56:57] op_sel:[1,1,0] op_sel_hi:[1,0,1] neg_lo:[1,0,0]
    v_pk_fma_f32 v[52:53], v[16:17], v[56:57], v[52:53] op_sel_hi:[0,1,1]
    v_pk_fma_f32 v[52:53], v[16:17], v[56:57], v[52:53] op_sel:[1,1,0] op_sel_hi:[1,0,1] neg_lo:[1,0,0]
    v_pk_fma_f32 v[48:49], v[16:17], v[52:53], v[48:49] op_sel_hi:[0,1,1]
    v_pk_fma_f32 v[48:49], v[16:17], v[52:53], v[48:49] op_sel:[1,1,0] op_sel_hi:[1,0,1] neg_lo:[1,0,0]
    v_pk_mov_b32 v[30:31], v[48:49], v[48:49] op_sel:[0,1]
    s_nop 1
    v_permlane32_swap_b32 v30, v48
    v_permlane32_swap_b32 v31, v49
    v_pk_fma_f32 v[30:31], v[18:19], v[48:49], v[30:31] op_sel_hi:[0,1,1]
    v_pk_fma_f32 v[30:31], v[18:19], v[48:49], v[30:31] op_sel:[1,1,0] op_sel_hi:[1,0,1] neg_lo:[1,0,0]
    s_cmp_le_u32 s48, 0
    s_cbranch_scc1 L_PG
    v_pk_fma_f32 v[2:3], v[14:15], v[30:31], v[2:3] op_sel_hi:[0,1,1]
    v_pk_fma_f32 v[2:3], v[14:15], v[30:31], v[2:3] op_sel:[1,1,0] op_sel_hi:[1,0,1] neg_lo:[1,0,0]
    v_pk_mov_b32 v[30:31], v[2:3], v[2:3] op_sel:[0,1]
    s_cmp_le_u32 s48, 1
    s_cbranch_scc1 L_PG
    v_pk_fma_f32 v[4:5], v[14:15], v[30:31], v[4:5] op_sel_hi:[0,1,1]
    v_pk_fma_f32 v[4:5], v[14:15], v[30:31], v[4:5] op_sel:[1,1,0] op_sel_hi:[1,0,1] neg_lo:[1,0,0]
    v_pk_mov_b32 v[30:31], v[4:5], v[4:5] op_sel:[0,1]
    s_cmp_le_u32 s48, 2
    s_cbranch_scc1 L_PG
    v_pk_fma_f32 v[6:7], v[14:15], v[30:31], v[6:7] op_sel_hi:[0,1,1]
    v_pk_fma_f32 v[6:7], v[14:15], v[30:31], v[6:7] op_sel:[1,1,0] op_sel_hi:[1,0,1] neg_lo:[1,0,0]
    v_pk_mov_b32 v[30:31], v[6:7], v[6:7] op_sel:[0,1]
L_PG:
    s_mov_b32 exec_lo, 0
    v_pk_fma_f32 v[44:45], v[12:13], v[30:31], v[44:45] op_sel_hi:[0,1,1]
    v_pk_fma_f32 v[44:45], v[12:13], v[30:31], v[44:45] op_sel:[1,1,0] op_sel_hi:[1,0,1] neg_lo:[1,0,0]
    v_pk_mov_b32 v[30:31], v[44:45], v[44:45] op_sel:[0,1]
    s_mov_b32 exec_lo, -1
    v_fma_f32 v25, v10, v30, v40
    v_fma_f32 v27, v10, v31, v42
    v_fma_f32 v25, -v11, v31, v25
    v_fmac_f32 v27, v11, v30
    v_mov_b32 v24, v30
    v_mov_b32 v26, v31
    v_pk_fma_f32 v[96:97], v[8:9], v[24:25], v[96:97] op_sel_hi:[0,1,1]
    v_pk_fma_f32 v[112:113], v[8:9], v[26:27], v[112:113] op_sel_hi:[0,1,1]
    v_pk_fma_f32 v[96:97], v[8:9], v[26:27], v[96:97] op_sel:[1,0,0] neg_lo:[1,0,0] neg_hi:[1,0,0]
    v_pk_fma_f32 v[112:113], v[8:9], v[24:25], v[112:113] op_sel:[1,0,0]
    v_pk_fma_f32 v[98:99], v[8:9], v[96:97], v[98:99] op_sel_hi:[0,1,1]
    v_pk_fma_f32 v[114:115], v[8:9], v[112:113], v[114:115] op_sel_hi:[0,1,1]
    v_pk_fma_f32 v[98:99], v[8:9], v[112:113], v[98:99] op_sel:[1,0,0] neg_lo:[1,0,0] neg_hi:[1,0,0]
    v_pk_fma_f32 v[114:115], v[8:9], v[96:97], v[114:115] op_sel:[1,0,0]
    v_pk_fma_f32 v[100:101], v[8:9], v[98:99], v[100:101] op_sel_hi:[0,1,1]
    v_pk_fma_f32 v[116:117], v[8:9], v[114:115], v[116:117] op_sel_hi:[0,1,1]
    v_pk_fma_f32 v[100:101], v[8:9], v[114:115], v[100:101] op_sel:[1,0,0] neg_lo:[1,0,0] neg_hi:[1,0,0]
    v_pk_fma_f32 v[116:117], v[8:9], v[98:99], v[116:117] op_sel:[1,0,0]
    v_pk_fma_f32 v[102:103], v[8:9], v[100:101], v[102:103] op_sel_hi:[0,1,1]
    v_pk_fma_f32 v[118:119], v[8:9], v[116:117], v[118:119] op_sel_hi:[0,1,1]
    v_pk_fma_f32 v[102:103], v[8:9], v[116:117], v[102:103] op_sel:[1,0,0] neg_lo:[1,0,0] neg_hi:[1,0,0]
    v_pk_fma_f32 v[118:119], v[8:9], v[100:101], v[118:119] op_sel:[1,0,0]
    v_pk_fma_f32 v[104:105], v[8:9], v[102:103], v[104:105] op_sel_hi:[0,1,1]
    v_pk_fma_f32 v[120:121], v[8:9], v[118:119], v[120:121] op_sel_hi:[0,1,1]
    v_pk_fma_f32 v[104:105], v[8:9], v[118:119], v[104:105] op_sel:[1,0,0] neg_lo:[1,0,0] neg_hi:[1,0,0]
    v_pk_fma_f32 v[120:121], v[8:9], v[102:103], v[120:121] op_sel:[1,0,0]
    v_pk_fma_f32 v[106:107], v[8:9], v[104:105], v[106:107] op_sel_hi:[0,1,1]
    v_pk_fma_f32 v[122:123], v[8:9], v[120:121], v[122:123] op_sel_hi:[0,1,1]
    v_pk_fma_f32 v[106:107], v[8:9], v[120:121], v[106:107] op_sel:[1,0,0] neg_lo:[1,0,0] neg_hi:[1,0,0]
    v_pk_fma_f32 v[122:123], v[8:9], v[104:105], v[122:123] op_sel:[1,0,0]
    v_pk_fma_f32 v[108:109], v[8:9], v[106:107], v[108:109] op_sel_hi:[0,1,1]
    v_pk_fma_f32 v[124:125], v[8:9], v[122:123], v[124:125] op_sel_hi:[0,1,1]
    v_pk_fma_f32 v[108:109], v[8:9], v[122:123], v[108:109] op_sel:[1,0,0] neg_lo:[1,0,0] neg_hi:[1,0,0]
    v_pk_fma_f32 v[124:125], v[8:9], v[106:107], v[124:125] op_sel:[1,0,0]
    v_pk_fma_f32 v[110:111], v[8:9], v[108:109], v[110:111] op_sel_hi:[0,1,1]
    v_pk_fma_f32 v[126:127], v[8:9], v[124:125], v[126:127] op_sel_hi:[0,1,1]
    v_pk_fma_f32 v[110:111], v[8:9], v[124:125], v[110:111] op_sel:[1,0,0] neg_lo:[1,0,0] neg_hi:[1,0,0]
    v_pk_fma_f32 v[126:127], v[8:9], v[108:109], v[126:127] op_sel:[1,0,0]
    v_cvt_pk_bf16_f32 v48, v96, v98
    v_cvt_pk_bf16_f32 v49, v100, v102
    v_cvt_pk_bf16_f32 v50, v104, v106
    v_cvt_pk_bf16_f32 v51, v108, v110
    v_cvt_pk_bf16_f32 v52, v97, v99
    v_cvt_pk_bf16_f32 v53, v101, v103
    v_cvt_pk_bf16_f32 v54, v105, v107
    v_cvt_pk_bf16_f32 v55, v109, v111
    v_cvt_pk_bf16_f32 v56, v112, v114
    v_cvt_pk_bf16_f32 v57, v116, v118
    v_cvt_pk_bf16_f32 v58, v120, v122
    v_cvt_pk_bf16_f32 v59, v124, v126
    v_cvt_pk_bf16_f32 v60, v113, v115
    v_cvt_pk_bf16_f32 v61, v117, v119
    v_cvt_pk_bf16_f32 v62, v121, v123
    v_cvt_pk_bf16_f32 v63, v125, v127
    ds_write_b128 v152, v[48:51]
    ds_write_b128 v152, v[52:55] offset:16
    ds_write_b128 v152, v[56:59] offset:2048
    ds_write_b128 v152, v[60:63] offset:2064
    s_mov_b32 s29, s93
    s_lshl_b32 s23, s92, 4
    s_add_u32 s23, s23, s27
    s_lshl_b32 s23, s23, 2
    s_add_u32 s30, s23, 36864
    s_and_b32 s25, s32, 62
    s_lshl_b32 s28, s25, 6
    s_lshl_b32 s24, s48, 4
    s_add_u32 s28, s28, s24
    s_add_u32 s28, s28, 36864
    s_lshl_b32 s24, s48, 14
    s_lshl_b32 s60, s32, 16
    s_add_u32 s60, s60, s24
    s_add_u32 s60, s60, 8388608
    s_lshl_b32 s59, s33, 16
    s_add_u32 s59, s59, s24
    s_add_u32 s59, s59, 1048576
    s_add_u32 s57, s19, s18
    s_lshl_b32 s57, s57, 12
    v_mov_b32 v29, s20
    s_waitcnt lgkmcnt(0)
    ds_read_b64_tr_b16 v[64:65], v153 offset:0
    ds_read_b64_tr_b16 v[66:67], v153 offset:256
    ds_read_b64_tr_b16 v[68:69], v153 offset:1024
    ds_read_b64_tr_b16 v[70:71], v153 offset:1280
    ds_read_b64_tr_b16 v[72:73], v153 offset:2048
    ds_read_b64_tr_b16 v[74:75], v153 offset:2304
    ds_read_b64_tr_b16 v[76:77], v153 offset:3072
    ds_read_b64_tr_b16 v[78:79], v153 offset:3328
    s_waitcnt lgkmcnt(0)
    buffer_store_dwordx4 v[64:67], v144, s[12:15], s29 offen offset:0 sc1
    buffer_store_dwordx4 v[68:71], v144, s[12:15], s29 offen offset:1024 sc1
    buffer_store_dwordx4 v[72:75], v144, s[12:15], s29 offen offset:2048 sc1
    buffer_store_dwordx4 v[76:79], v144, s[12:15], s29 offen offset:3072 sc1
    s_waitcnt vmcnt(0)
    s_mov_b64 exec, 1
    s_cmp_eq_u32 s22, 0
    s_cbranch_scc1 L_safe30
    buffer_store_dword v29, off, s[12:15], s30
    s_branch L_done31
L_safe30:
    buffer_store_dword v29, off, s[12:15], s30 sc1
L_done31:
    s_mov_b64 exec, -1
    v_mov_b32 v16, v144
    v_mov_b32 v17, v146
    v_mov_b32 v18, v147
    v_mov_b32 v19, v155
    v_mov_b32 v21, v157
    v_mov_b32 v30, v158
    v_mov_b32 v31, v159
    s_lshl_b32 s23, s19, 16
    s_lshl_b32 s54, s48, 14
    s_add_u32 s23, s23, s54
    s_add_u32 s53, s23, 524288
    s_mov_b32 s47, 0
L_hb32:
    ds_read_b32 v20, v17 offset:144
    s_add_u32 s47, s47, 1
    s_cmp_gt_u32 s47, 2097152
    s_cbranch_scc1 L_hd33
    s_waitcnt lgkmcnt(0)
    v_cmp_gt_u32 vcc, 8, v20
    s_nop 1
    s_cbranch_vccz L_hd33
    s_branch L_hb32
L_hd33:
    s_mov_b32 m0, s54
    s_add_u32 s54, s54, 4096
    buffer_load_dwordx4 v16, s[12:15], s53 offen offset:0 sc1 lds
    buffer_load_dwordx4 v16, s[12:15], s53 offen offset:1024 sc1 lds
    buffer_load_dwordx4 v16, s[12:15], s53 offen offset:2048 sc1 lds
    buffer_load_dwordx4 v16, s[12:15], s53 offen offset:3072 sc1 lds
    s_add_u32 s53, s53, 4096
    s_mov_b32 m0, s54
    s_add_u32 s54, s54, 4096
    buffer_load_dwordx4 v16, s[12:15], s53 offen offset:0 sc1 lds
    buffer_load_dwordx4 v16, s[12:15], s53 offen offset:1024 sc1 lds
    buffer_load_dwordx4 v16, s[12:15], s53 offen offset:2048 sc1 lds
    buffer_load_dwordx4 v16, s[12:15], s53 offen offset:3072 sc1 lds
    s_add_u32 s53, s53, 4096
    s_mov_b32 m0, s54
    s_add_u32 s54, s54, 4096
    buffer_load_dwordx4 v16, s[12:15], s53 offen offset:0 sc1 lds
    buffer_load_dwordx4 v16, s[12:15], s53 offen offset:1024 sc1 lds
    buffer_load_dwordx4 v16, s[12:15], s53 offen offset:2048 sc1 lds
    buffer_load_dwordx4 v16, s[12:15], s53 offen offset:3072 sc1 lds
    s_add_u32 s53, s53, 4096
    s_mov_b32 m0, s54
    s_add_u32 s54, s54, 4096
    buffer_load_dwordx4 v16, s[12:15], s53 offen offset:0 sc1 lds
    buffer_load_dwordx4 v16, s[12:15], s53 offen offset:1024 sc1 lds
    buffer_load_dwordx4 v16, s[12:15], s53 offen offset:2048 sc1 lds
    buffer_load_dwordx4 v16, s[12:15], s53 offen offset:3072 sc1 lds
    s_add_u32 s53, s53, 4096
    s_mov_b32 s47, 0
L_poll34:
    buffer_load_dword v25, v154, s[12:15], s28 offen sc1
    s_add_u32 s47, s47, 1
    s_cmp_gt_u32 s47, 2097152
    s_cbranch_scc1 L_pd35
    s_waitcnt vmcnt(0)
    v_cmp_ne_u32 vcc, s20, v25
    s_nop 1
    s_cbranch_vccnz L_poll34
L_pd35:
    s_waitcnt vmcnt(0)
    s_mov_b64 exec, 1
    ds_add_u32 v17, v18 offset:36
    ds_add_u32 v17, v18 offset:96
    s_mov_b64 exec, -1
    s_setprio 3
    s_add_u32 s57, s57, 4096
    s_and_b32 s57, s57, 0x3fff
    s_add_u32 s53, s59, s57
    s_add_u32 s54, s60, s57
    s_xor_b32 s55, s53, 65536
    s_xor_b32 s56, s54, 65536
    buffer_load_dwordx4 v[36:39], v16, s[12:15], s54 offen offset:0 sc1
    buffer_load_dwordx4 v[32:35], v16, s[12:15], s53 offen offset:0 sc1
    buffer_load_dwordx4 v[40:43], v16, s[12:15], s55 offen offset:0 sc1
    buffer_load_dwordx4 v[44:47], v16, s[12:15], s56 offen offset:0 sc1
    buffer_load_dwordx4 v[52:55], v16, s[12:15], s54 offen offset:1024 sc1
    buffer_load_dwordx4 v[48:51], v16, s[12:15], s53 offen offset:1024 sc1
    buffer_load_dwordx4 v[56:59], v16, s[12:15], s55 offen offset:1024 sc1
    buffer_load_dwordx4 v[60:63], v16, s[12:15], s56 offen offset:1024 sc1
    buffer_load_dwordx4 v[68:71], v16, s[12:15], s54 offen offset:2048 sc1
    buffer_load_dwordx4 v[64:67], v16, s[12:15], s53 offen offset:2048 sc1
    buffer_load_dwordx4 v[72:75], v16, s[12:15], s55 offen offset:2048 sc1
    buffer_load_dwordx4 v[76:79], v16, s[12:15], s56 offen offset:2048 sc1
    buffer_load_dwordx4 v[84:87], v16, s[12:15], s54 offen offset:3072 sc1
    buffer_load_dwordx4 v[80:83], v16, s[12:15], s53 offen offset:3072 sc1
    buffer_load_dwordx4 v[88:91], v16, s[12:15], s55 offen offset:3072 sc1
    buffer_load_dwordx4 v[92:95], v16, s[12:15], s56 offen offset:3072 sc1
    s_add_u32 s57, s57, 4096
    s_and_b32 s57, s57, 0x3fff
    s_add_u32 s53, s59, s57
    s_add_u32 s54, s60, s57
    s_xor_b32 s55, s53, 65536
    s_xor_b32 s56, s54, 65536
    s_waitcnt vmcnt(14)
    v_mfma_f32_32x32x16_bf16 v[96:111], v[32:35], v[36:39], 0
    s_waitcnt vmcnt(13)
    v_mfma_f32_32x32x16_bf16 v[112:127], v[40:43], v[36:39], 0
    buffer_load_dwordx4 v[36:39], v16, s[12:15], s54 offen offset:0 sc1
    s_waitcnt vmcnt(13)
    v_mfma_f32_32x32x16_bf16 v[128:143], v[32:35], v[44:47], 0
    buffer_load_dwordx4 v[32:35], v16, s[12:15], s53 offen offset:0 sc1
    v_mfma_f32_32x32x16_bf16 v[144:159], v[40:43], v[44:47], 0
    buffer_load_dwordx4 v[40:43], v16, s[12:15], s55 offen offset:0 sc1
    buffer_load_dwordx4 v[44:47], v16, s[12:15], s56 offen offset:0 sc1
    s_waitcnt vmcnt(14)
    v_mfma_f32_32x32x16_bf16 v[96:111], v[48:51], v[52:55], v[96:111]
    s_waitcnt vmcnt(13)
    v_mfma_f32_32x32x16_bf16 v[112:127], v[56:59], v[52:55], v[112:127]
    buffer_load_dwordx4 v[52:55], v16, s[12:15], s54 offen offset:1024 sc1
    s_waitcnt vmcnt(13)
    v_mfma_f32_32x32x16_bf16 v[128:143], v[48:51], v[60:63], v[128:143]
    buffer_load_dwordx4 v[48:51], v16, s[12:15], s53 offen offset:1024 sc1
    v_mfma_f32_32x32x16_bf16 v[144:159], v[56:59], v[60:63], v[144:159]
    buffer_load_dwordx4 v[56:59], v16, s[12:15], s55 offen offset:1024 sc1
    buffer_load_dwordx4 v[60:63], v16, s[12:15], s56 offen offset:1024 sc1
    s_waitcnt vmcnt(14)
    v_mfma_f32_32x32x16_bf16 v[96:111], v[64:67], v[68:71], v[96:111]
    s_waitcnt vmcnt(13)
    v_mfma_f32_32x32x16_bf16 v[112:127], v[72:75], v[68:71], v[112:127]
    buffer_load_dwordx4 v[68:71], v16, s[12:15], s54 offen offset:2048 sc1
    s_waitcnt vmcnt(13)
    v_mfma_f32_32x32x16_bf16 v[128:143], v[64:67], v[76:79], v[128:143]
    buffer_load_dwordx4 v[64:67], v16, s[12:15], s53 offen offset:2048 sc1
    v_mfma_f32_32x32x16_bf16 v[144:159], v[72:75], v[76:79], v[144:159]
    buffer_load_dwordx4 v[72:75], v16, s[12:15], s55 offen offset:2048 sc1
    buffer_load_dwordx4 v[76:79], v16, s[12:15], s56 offen offset:2048 sc1
    s_waitcnt vmcnt(14)
    v_mfma_f32_32x32x16_bf16 v[96:111], v[80:83], v[84:87], v[96:111]
    s_waitcnt vmcnt(13)
    v_mfma_f32_32x32x16_bf16 v[112:127], v[88:91], v[84:87], v[112:127]
    buffer_load_dwordx4 v[84:87], v16, s[12:15], s54 offen offset:3072 sc1
    s_waitcnt vmcnt(13)
    v_mfma_f32_32x32x16_bf16 v[128:143], v[80:83], v[92:95], v[128:143]
    buffer_load_dwordx4 v[80:83], v16, s[12:15], s53 offen offset:3072 sc1
    v_mfma_f32_32x32x16_bf16 v[144:159], v[88:91], v[92:95], v[144:159]
    buffer_load_dwordx4 v[88:91], v16, s[12:15], s55 offen offset:3072 sc1
    buffer_load_dwordx4 v[92:95], v16, s[12:15], s56 offen offset:3072 sc1
    s_mov_b32 s58, 0
L_Y:
    s_add_u32 s57, s57, 4096
    s_and_b32 s57, s57, 0x3fff
    s_add_u32 s53, s59, s57
    s_add_u32 s54, s60, s57
    s_xor_b32 s55, s53, 65536
    s_xor_b32 s56, s54, 65536
    s_waitcnt vmcnt(14)
    v_mfma_f32_32x32x16_bf16 v[96:111], v[32:35], v[36:39], v[96:111]
    s_waitcnt vmcnt(13)
    v_mfma_f32_32x32x16_bf16 v[112:127], v[40:43], v[36:39], v[112:127]
    buffer_load_dwordx4 v[36:39], v16, s[12:15], s54 offen offset:0 sc1
    s_waitcnt vmcnt(13)
    v_mfma_f32_32x32x16_bf16 v[128:143], v[32:35], v[44:47], v[128:143]
    buffer_load_dwordx4 v[32:35], v16, s[12:15], s53 offen offset:0 sc1
    v_mfma_f32_32x32x16_bf16 v[144:159], v[40:43], v[44:47], v[144:159]
    buffer_load_dwordx4 v[40:43], v16, s[12:15], s55 offen offset:0 sc1
    buffer_load_dwordx4 v[44:47], v16, s[12:15], s56 offen offset:0 sc1
    s_waitcnt vmcnt(14)
    v_mfma_f32_32x32x16_bf16 v[96:111], v[48:51], v[52:55], v[96:111]
    s_waitcnt vmcnt(13)
    v_mfma_f32_32x32x16_bf16 v[112:127], v[56:59], v[52:55], v[112:127]
    buffer_load_dwordx4 v[52:55], v16, s[12:15], s54 offen offset:1024 sc1
    s_waitcnt vmcnt(13)
    v_mfma_f32_32x32x16_bf16 v[128:143], v[48:51], v[60:63], v[128:143]
    buffer_load_dwordx4 v[48:51], v16, s[12:15], s53 offen offset:1024 sc1
    v_mfma_f32_32x32x16_bf16 v[144:159], v[56:59], v[60:63], v[144:159]
    buffer_load_dwordx4 v[56:59], v16, s[12:15], s55 offen offset:1024 sc1
    buffer_load_dwordx4 v[60:63], v16, s[12:15], s56 offen offset:1024 sc1
    s_waitcnt vmcnt(14)
    v_mfma_f32_32x32x16_bf16 v[96:111], v[64:67], v[68:71], v[96:111]
    s_waitcnt vmcnt(13)
    v_mfma_f32_32x32x16_bf16 v[112:127], v[72:75], v[68:71], v[112:127]
    buffer_load_dwordx4 v[68:71], v16, s[12:15], s54 offen offset:2048 sc1
    s_waitcnt vmcnt(13)
    v_mfma_f32_32x32x16_bf16 v[128:143], v[64:67], v[76:79], v[128:143]
    buffer_load_dwordx4 v[64:67], v16, s[12:15], s53 offen offset:2048 sc1
    v_mfma_f32_32x32x16_bf16 v[144:159], v[72:75], v[76:79], v[144:159]
    buffer_load_dwordx4 v[72:75], v16, s[12:15], s55 offen offset:2048 sc1
    buffer_load_dwordx4 v[76:79], v16, s[12:15], s56 offen offset:2048 sc1
    s_waitcnt vmcnt(14)
    v_mfma_f32_32x32x16_bf16 v[96:111], v[80:83], v[84:87], v[96:111]
    s_waitcnt vmcnt(13)
    v_mfma_f32_32x32x16_bf16 v[112:127], v[88:91], v[84:87], v[112:127]
    buffer_load_dwordx4 v[84:87], v16, s[12:15], s54 offen offset:3072 sc1
    s_waitcnt vmcnt(13)
    v_mfma_f32_32x32x16_bf16 v[128:143], v[80:83], v[92:95], v[128:143]
    buffer_load_dwordx4 v[80:83], v16, s[12:15], s53 offen offset:3072 sc1
    v_mfma_f32_32x32x16_bf16 v[144:159], v[88:91], v[92:95], v[144:159]
    buffer_load_dwordx4 v[88:91], v16, s[12:15], s55 offen offset:3072 sc1
    buffer_load_dwordx4 v[92:95], v16, s[12:15], s56 offen offset:3072 sc1
    s_add_u32 s58, s58, 1
    s_cmp_lt_u32 s58, 2
    s_cbranch_scc1 L_Y
    s_mov_b32 s23, 8192
    s_mov_b32 s24, 16384
    s_mov_b32 s25, 24576
    buffer_load_dwordx2 v[8:9], v19, s[40:43], 0 offen
    buffer_load_dwordx2 v[10:11], v19, s[40:43], s23 offen
    buffer_load_dwordx2 v[12:13], v19, s[40:43], s24 offen
    buffer_load_dwordx2 v[14:15], v19, s[40:43], s25 offen
    s_lshl_b32 s23, s16, 2
    s_add_u32 s23, s23, s48
    s_lshl_b32 s23, s23, 8
    s_add_u32 s23, s23, 40960
    v_lshlrev_b32 v25, 7, v1
    s_mov_b64 exec, 3
    buffer_load_dword v163, v25, s[12:15], s23 offen sc1
    s_mov_b64 exec, -1
    s_lshl_b32 s23, s17, 7
    s_add_u32 s23, s23, L_AE-L_START
    s_min_u32 s23, s23, L_CODE_END-L_START-4
    v_mov_b32 v25, s23
    s_mov_b64 exec, 1
    global_load_dword v163, v25, s[82:83]
    s_mov_b64 exec, -1
    s_waitcnt vmcnt(20)
    v_mfma_f32_32x32x16_bf16 v[96:111], v[32:35], v[36:39], v[96:111]
    s_waitcnt vmcnt(19)
    v_mfma_f32_32x32x16_bf16 v[112:127], v[40:43], v[36:39], v[112:127]
    s_waitcnt vmcnt(18)
    v_mfma_f32_32x32x16_bf16 v[128:143], v[32:35], v[44:47], v[128:143]
    v_mfma_f32_32x32x16_bf16 v[144:159], v[40:43], v[44:47], v[144:159]
    s_waitcnt vmcnt(16)
    v_mfma_f32_32x32x16_bf16 v[96:111], v[48:51], v[52:55], v[96:111]
    s_waitcnt vmcnt(15)
    v_mfma_f32_32x32x16_bf16 v[112:127], v[56:59], v[52:55], v[112:127]
    s_waitcnt vmcnt(14)
    v_mfma_f32_32x32x16_bf16 v[128:143], v[48:51], v[60:63], v[128:143]
    v_mfma_f32_32x32x16_bf16 v[144:159], v[56:59], v[60:63], v[144:159]
    s_waitcnt vmcnt(12)
    v_mfma_f32_32x32x16_bf16 v[96:111], v[64:67], v[68:71], v[96:111]
    s_waitcnt vmcnt(11)
    v_mfma_f32_32x32x16_bf16 v[112:127], v[72:75], v[68:71], v[112:127]
    s_waitcnt vmcnt(10)
    v_mfma_f32_32x32x16_bf16 v[128:143], v[64:67], v[76:79], v[128:143]
    v_mfma_f32_32x32x16_bf16 v[144:159], v[72:75], v[76:79], v[144:159]
    s_waitcnt vmcnt(8)
    v_mfma_f32_32x32x16_bf16 v[96:111], v[80:83], v[84:87], v[96:111]
    s_waitcnt vmcnt(7)
    v_mfma_f32_32x32x16_bf16 v[112:127], v[88:91], v[84:87], v[112:127]
    s_waitcnt vmcnt(6)
    v_mfma_f32_32x32x16_bf16 v[128:143], v[80:83], v[92:95], v[128:143]
    v_mfma_f32_32x32x16_bf16 v[144:159], v[88:91], v[92:95], v[144:159]
    s_setprio 3
    s_mov_b32 s36, s86
    s_mov_b32 s37, s87
    s_mov_b32 s38, 0x800000
    s_mov_b32 s39, 0x20000
    s_xor_b32 s23, s48, 2
    s_lshl_b32 s23, s23, 12
    s_add_u32 s23, s23, 65536
    v_add_u32 v24, s23, v16
    s_xor_b32 s23, s48, 1
    s_lshl_b32 s23, s23, 12
    s_add_u32 s23, s23, 81920
    v_add_u32 v25, s23, v16
    s_xor_b32 s23, s34, 12288
    v_add_u32 v26, s23, v16
    s_sub_u32 s23, s34, 65536
    v_add_u32 v27, s23, v16
    v_add_u32 v28, s34, v16
    s_mov_b32 s47, 0
L_hb36:
    ds_read_b32 v20, v17 offset:96
    s_add_u32 s47, s47, 1
    s_cmp_gt_u32 s47, 2097152
    s_cbranch_scc1 L_hd37
    s_waitcnt lgkmcnt(0)
    v_cmp_gt_u32 vcc, 4, v20
    s_nop 1
    s_cbranch_vccz L_hd37
    s_branch L_hb36
L_hd37:
    s_mov_b32 s47, 0
L_hb38:
    ds_read_b32 v20, v17 offset:152
    s_add_u32 s47, s47, 1
    s_cmp_gt_u32 s47, 2097152
    s_cbranch_scc1 L_hd39
    s_waitcnt lgkmcnt(0)
    v_cmp_gt_u32 vcc, 8, v20
    s_nop 1
    s_cbranch_vccz L_hd39
    s_branch L_hb38
L_hd39:
    ds_write_b128 v24, v[112:115] offset:0
    ds_write_b128 v24, v[116:119] offset:1024
    ds_write_b128 v24, v[120:123] offset:2048
    ds_write_b128 v24, v[124:127] offset:3072
    ds_write_b128 v25, v[128:131] offset:0
    ds_write_b128 v25, v[132:135] offset:1024
    ds_write_b128 v25, v[136:139] offset:2048
    ds_write_b128 v25, v[140:143] offset:3072
    ds_write_b128 v26, v[144:147] offset:0
    ds_write_b128 v26, v[148:151] offset:1024
    ds_write_b128 v26, v[152:155] offset:2048
    ds_write_b128 v26, v[156:159] offset:3072
    s_waitcnt vmcnt(2) lgkmcnt(0)
    s_mov_b64 exec, 1
    ds_add_u32 v17, v18 offset:48
    s_mov_b64 exec, -1
    s_mov_b32 s47, 0
L_hb40:
    ds_read_b32 v20, v17 offset:48
    s_add_u32 s47, s47, 1
    s_cmp_gt_u32 s47, 2097152
    s_cbranch_scc1 L_hd41
    s_waitcnt lgkmcnt(0)
    v_cmp_gt_u32 vcc, 4, v20
    s_nop 1
    s_cbranch_vccz L_hd41
    s_branch L_hb40
L_hd41:
    ds_read_b128 v[32:35], v27 offset:0
    ds_read_b128 v[36:39], v27 offset:1024
    ds_read_b128 v[40:43], v27 offset:2048
    ds_read_b128 v[44:47], v27 offset:3072
    ds_read_b128 v[48:51], v27 offset:16384
    ds_read_b128 v[52:55], v27 offset:17408
    ds_read_b128 v[56:59], v27 offset:18432
    ds_read_b128 v[60:63], v27 offset:19456
    ds_read_b128 v[64:67], v28 offset:0
    ds_read_b128 v[68:71], v28 offset:1024
    ds_read_b128 v[72:75], v28 offset:2048
    ds_read_b128 v[76:79], v28 offset:3072
    v_xor_b32 v25, 32, v21
    v_xor_b32 v26, 64, v21
    v_xor_b32 v27, 96, v21
    s_waitcnt lgkmcnt(4)
    v_pk_add_f32 v[96:97], v[96:97], v[32:33]
    v_pk_add_f32 v[98:99], v[98:99], v[34:35]
    v_pk_add_f32 v[100:101], v[100:101], v[36:37]
    v_pk_add_f32 v[102:103], v[102:103], v[38:39]
    v_pk_add_f32 v[104:105], v[104:105], v[40:41]
    v_pk_add_f32 v[106:107], v[106:107], v[42:43]
    v_pk_add_f32 v[108:109], v[108:109], v[44:45]
    v_pk_add_f32 v[110:111], v[110:111], v[46:47]
    v_pk_add_f32 v[96:97], v[96:97], v[48:49]
    v_pk_add_f32 v[98:99], v[98:99], v[50:51]
    v_pk_add_f32 v[100:101], v[100:101], v[52:53]
    v_pk_add_f32 v[102:103], v[102:103], v[54:55]
    v_pk_add_f32 v[104:105], v[104:105], v[56:57]
    v_pk_add_f32 v[106:107], v[106:107], v[58:59]
    v_pk_add_f32 v[108:109], v[108:109], v[60:61]
    v_pk_add_f32 v[110:111], v[110:111], v[62:63]
    s_waitcnt lgkmcnt(0)
    v_pk_add_f32 v[96:97], v[96:97], v[64:65]
    v_pk_add_f32 v[98:99], v[98:99], v[66:67]
    v_pk_add_f32 v[100:101], v[100:101], v[68:69]
    v_pk_add_f32 v[102:103], v[102:103], v[70:71]
    v_pk_add_f32 v[104:105], v[104:105], v[72:73]
    v_pk_add_f32 v[106:107], v[106:107], v[74:75]
    v_pk_add_f32 v[108:109], v[108:109], v[76:77]
    v_pk_add_f32 v[110:111], v[110:111], v[78:79]
    ds_write_b128 v21, v[96:99]
    ds_write_b128 v25, v[100:103]
    ds_write_b128 v26, v[104:107]
    ds_write_b128 v27, v[108:111]
    s_waitcnt lgkmcnt(0)
    s_lshl_b32 s23, s32, 17
    s_lshl_b32 s24, s33, 7
    s_add_u32 s23, s23, s24
    ds_read_b128 v[32:35], v30 offset:0
    ds_read_b128 v[36:39], v30 offset:1024
    ds_read_b128 v[40:43], v30 offset:2048
    ds_read_b128 v[44:47], v30 offset:3072
    v_lshlrev_b32 v22, 16, v160
    v_and_b32 v23, 0xffff0000, v160
    v_lshlrev_b32 v24, 16, v161
    v_and_b32 v25, 0xffff0000, v161
    v_lshlrev_b32 v26, 16, v8
    v_and_b32 v27, 0xffff0000, v8
    v_lshlrev_b32 v28, 16, v9
    v_and_b32 v29, 0xffff0000, v9
    s_waitcnt lgkmcnt(3)
    v_pk_fma_f32 v[32:33], v[26:27], v[22:23], v[32:33]
    v_pk_fma_f32 v[34:35], v[28:29], v[24:25], v[34:35]
    buffer_store_dwordx4 v[32:35], v31, s[36:39], s23 offen sc1
    s_add_u32 s23, s23, 32768
    v_lshlrev_b32 v26, 16, v10
    v_and_b32 v27, 0xffff0000, v10
    v_lshlrev_b32 v28, 16, v11
    v_and_b32 v29, 0xffff0000, v11
    s_waitcnt lgkmcnt(2)
    v_pk_fma_f32 v[36:37], v[26:27], v[22:23], v[36:37]
    v_pk_fma_f32 v[38:39], v[28:29], v[24:25], v[38:39]
    buffer_store_dwordx4 v[36:39], v31, s[36:39], s23 offen sc1
    s_add_u32 s23, s23, 32768
    v_lshlrev_b32 v26, 16, v12
    v_and_b32 v27, 0xffff0000, v12
    v_lshlrev_b32 v28, 16, v13
    v_and_b32 v29, 0xffff0000, v13
    s_waitcnt lgkmcnt(1)
    v_pk_fma_f32 v[40:41], v[26:27], v[22:23], v[40:41]
    v_pk_fma_f32 v[42:43], v[28:29], v[24:25], v[42:43]
    buffer_store_dwordx4 v[40:43], v31, s[36:39], s23 offen sc1
    s_add_u32 s23, s23, 32768
    v_lshlrev_b32 v26, 16, v14
    v_and_b32 v27, 0xffff0000, v14
    v_lshlrev_b32 v28, 16, v15
    v_and_b32 v29, 0xffff0000, v15
    s_waitcnt lgkmcnt(0)
    v_pk_fma_f32 v[44:45], v[26:27], v[22:23], v[44:45]
    v_pk_fma_f32 v[46:47], v[28:29], v[24:25], v[46:47]
    buffer_store_dwordx4 v[44:47], v31, s[36:39], s23 offen sc1
    s_endpgm
L_ATT:
    s_and_b32 s48, s3, 1
    s_lshr_b32 s49, s3, 1
    s_and_b32 s49, s49, 1
    s_mov_b32 s44, 0xffff
    s_mov_b32 s45, 0xffff
    v_and_b32 v8, 31, v1
    v_lshrrev_b32 v9, 1, v8
    v_lshrrev_b32 v2, 5, v1
    v_xor_b32 v9, v9, v2
    v_and_b32 v9, 7, v9
    v_lshlrev_b32 v9, 4, v9
    v_lshl_add_u32 v2, v8, 7, v9
    v_xor_b32 v3, 32, v2
    v_xor_b32 v4, 64, v2
    v_xor_b32 v5, 96, v2
    s_lshl_b32 s23, s49, 12
    v_add_u32 v2, s23, v2
    v_add_u32 v3, s23, v3
    v_add_u32 v4, s23, v4
    v_add_u32 v5, s23, v5
    v_bfe_u32 v8, v1, 2, 2
    v_lshrrev_b32 v9, 5, v1
    v_lshl_add_u32 v9, v9, 3, v8
    v_lshlrev_b32 v6, 7, v9
    v_bfe_u32 v9, v1, 4, 1
    s_lshl_b32 s23, s48, 1
    v_add_u32 v9, s23, v9
    v_and_b32 v8, 2, v8
    v_xor_b32 v9, v9, v8
    v_lshl_add_u32 v6, v9, 5, v6
    v_and_b32 v8, 3, v1
    s_waitcnt lgkmcnt(0)
    s_load_dword s21, s[12:13], 0
    v_mov_b32 v80, 0
    v_mov_b32 v81, 0
    v_mov_b32 v82, 0
    v_mov_b32 v83, 0
    v_mov_b32 v84, 0
    v_mov_b32 v85, 0
    v_mov_b32 v86, 0
    v_mov_b32 v87, 0
    v_mov_b32 v88, 0
    v_mov_b32 v89, 0
    v_mov_b32 v90, 0
    v_mov_b32 v91, 0
    v_mov_b32 v92, 0
    v_mov_b32 v93, 0
    v_mov_b32 v94, 0
    v_mov_b32 v95, 0
    s_lshl_b32 s23, s16, 2
    s_add_u32 s23, s23, s18
    s_lshl_b32 s23, s23, 1
    s_add_u32 s51, s23, s49
    s_lshr_b32 s25, s3, 2
    s_mul_i32 s23, s25, 4
    s_add_u32 s23, s23, s19
    s_and_b32 s23, s23, 7
    s_lshl_b32 s23, s23, 1
    s_add_u32 s61, s23, s48
    s_lshl_b32 s52, s61, 18
    s_lshl_b32 s24, s51, 11
    s_add_u32 s50, s52, s24
    s_lshl_b32 s23, s18, 1
    s_add_u32 s23, s23, s25
    s_lshl_b32 s23, s23, 2
    s_lshr_b32 s26, s61, 1
    s_lshl_b32 s24, s16, 3
    s_add_u32 s24, s24, s26
    s_lshl_b32 s24, s24, 7
    s_add_u32 s59, s24, s23
    s_add_u32 s59, s59, 16384
    s_lshl_b32 s24, s26, 3
    s_add_u32 s24, s24, s16
    s_lshl_b32 s24, s24, 7
    s_add_u32 s60, s24, s23
    s_add_u32 s60, s60, 8192
    v_lshlrev_b32 v11, 4, v1
    s_lshl_b32 s30, s3, 11
    s_lshl_b32 s23, s17, 17
    s_add_u32 s23, s23, s30
    s_add_u32 s62, s23, 2097152
    s_lshl_b32 s24, s16, 14
    s_add_u32 s29, s62, s24
    s_lshl_b32 s23, s16, 3
    s_add_u32 s23, s23, s19
    s_lshl_b32 s23, s23, 7
    s_add_u32 s28, s23, 16384
    s_lshl_b32 s23, s19, 3
    s_add_u32 s23, s23, s16
    s_lshl_b32 s23, s23, 7
    s_add_u32 s31, s23, 8192
    s_and_b32 s24, s3, 3
    s_lshl_b32 s24, s24, 1
    s_add_u32 s24, s24, s25
    s_lshl_b32 s23, s16, 3
    s_add_u32 s34, s23, s24
    s_lshl_b32 s23, s17, 6
    s_add_u32 s23, s23, s34
    s_lshl_b32 s23, s23, 10
    s_add_u32 s33, s23, 6291456
    v_mov_b32 v144, v11
    v_mov_b32 v145, 1
    s_waitcnt lgkmcnt(0)
    s_mul_i32 s20, s21, 0x9E3779B1
    s_add_u32 s20, s20, 0x7F4A7C15
    v_mov_b32 v10, s20
    s_cmp_ge_u32 s3, 4
    s_cbranch_scc1 L_VPRE
    v_lshrrev_b32 v9, 1, v8
    v_lshlrev_b32 v8, 1, v8
    v_and_b32 v8, 2, v8
    v_or_b32 v9, v9, v8
    v_lshl_add_u32 v6, v9, 3, v6
    v_mov_b32 v108, 0
    v_mov_b32 v109, 0
    v_mov_b32 v110, 0
    v_mov_b32 v111, 0
    v_mov_b32 v112, 0
    v_mov_b32 v113, 0
    v_mov_b32 v114, 0
    v_mov_b32 v115, 0
    v_mov_b32 v116, 0
    v_mov_b32 v117, 0
    v_mov_b32 v118, 0
    v_mov_b32 v119, 0
    v_mov_b32 v120, 0
    v_mov_b32 v121, 0
    v_mov_b32 v122, 0
    v_mov_b32 v123, 0
    v_mov_b32 v14, v11
    s_add_u32 s53, s50, 2097152
    s_add_u32 s54, s53, 131072
    s_add_u32 s23, s19, 2
    s_and_b32 s26, s23, 7
    s_lshl_b32 s23, s26, 1
    s_add_u32 s23, s23, s48
    s_lshl_b32 s23, s23, 17
    s_lshl_b32 s24, s51, 10
    s_add_u32 s23, s23, s24
    s_add_u32 s88, s23, 6291456
    s_add_u32 s89, s88, 65536
    s_lshl_b32 s23, s18, 2
    s_add_u32 s23, s23, 32
    s_lshl_b32 s24, s16, 3
    s_add_u32 s24, s24, s26
    s_lshl_b32 s24, s24, 7
    s_add_u32 s40, s24, s23
    s_add_u32 s40, s40, 16384
    s_lshl_b32 s24, s26, 3
    s_add_u32 s24, s24, s16
    s_lshl_b32 s24, s24, 7
    s_add_u32 s41, s24, s23
    s_add_u32 s41, s41, 8192
    s_mov_b32 s58, 0
    s_mov_b32 s56, 65536
L_K:
    s_add_u32 s24, s56, 16384
    s_cmp_eq_u32 s58, 7
    s_cselect_b32 s24, 65536, s24
    v_add_u32 v7, s56, v6
    v_add_u32 v9, s24, v6
    s_barrier
    ds_read_b128 v[16:19], v2
    ds_read_b64_tr_b16 v[20:21], v7 offset:0
    ds_read_b64_tr_b16 v[22:23], v7 offset:512
    ds_read_b64_tr_b16 v[24:25], v9 offset:0
    ds_read_b64_tr_b16 v[26:27], v9 offset:512
    ds_read_b128 v[28:31], v3
    ds_read_b64_tr_b16 v[32:33], v7 offset:2048
    ds_read_b64_tr_b16 v[34:35], v7 offset:2560
    ds_read_b64_tr_b16 v[36:37], v9 offset:2048
    ds_read_b64_tr_b16 v[38:39], v9 offset:2560
    s_add_u32 s56, s56, 24576
    s_cmp_ge_u32 s56, 163840
    s_cselect_b32 s23, 98304, 0
    s_sub_u32 s56, s56, s23
    s_waitcnt lgkmcnt(5)
    v_mfma_f32_32x32x16_bf16 v[80:95], v[20:23], v[16:19], v[80:95]
    v_mfma_f32_32x32x16_bf16 v[108:123], v[24:27], v[16:19], v[108:123]
    ds_read_b128 v[40:43], v4
    ds_read_b64_tr_b16 v[44:45], v7 offset:4096
    ds_read_b64_tr_b16 v[46:47], v7 offset:4608
    ds_read_b64_tr_b16 v[48:49], v9 offset:4096
    ds_read_b64_tr_b16 v[50:51], v9 offset:4608
    s_waitcnt lgkmcnt(5)
    v_mfma_f32_32x32x16_bf16 v[80:95], v[32:35], v[28:31], v[80:95]
    v_mfma_f32_32x32x16_bf16 v[108:123], v[36:39], v[28:31], v[108:123]
    ds_read_b128 v[16:19], v5
    ds_read_b64_tr_b16 v[20:21], v7 offset:6144
    ds_read_b64_tr_b16 v[22:23], v7 offset:6656
    ds_read_b64_tr_b16 v[24:25], v9 offset:6144
    ds_read_b64_tr_b16 v[26:27], v9 offset:6656
    v_add_u32 v2, 8192, v2
    v_add_u32 v3, 8192, v3
    v_add_u32 v4, 8192, v4
    v_add_u32 v5, 8192, v5
    s_waitcnt lgkmcnt(5)
    v_mfma_f32_32x32x16_bf16 v[80:95], v[44:47], v[40:43], v[80:95]
    v_mfma_f32_32x32x16_bf16 v[108:123], v[48:51], v[40:43], v[108:123]
    s_add_u32 s58, s58, 1
    s_cmp_eq_u32 s58, 8
    s_waitcnt lgkmcnt(0)
    s_cbranch_scc1 L_Ke
    v_mfma_f32_32x32x16_bf16 v[80:95], v[20:23], v[16:19], v[80:95]
    v_mfma_f32_32x32x16_bf16 v[108:123], v[24:27], v[16:19], v[108:123]
    s_branch L_K
L_Ke:
    s_barrier
    v_mfma_f32_32x32x16_bf16 v[80:95], v[20:23], v[16:19], v[80:95]
    v_mfma_f32_32x32x16_bf16 v[108:123], v[24:27], v[16:19], v[108:123]
    v_mov_b32 v8, 0x3eb8aa3b
    v_and_b32 v9, 31, v1
    v_lshlrev_b32 v9, 3, v9
    s_lshl_b32 s23, s16, 8
    s_add_u32 s23, s23, 4096
    buffer_load_dwordx2 v[12:13], v9, s[12:15], s23 offen sc1
    s_nop 4
    v_cvt_pk_bf16_f32 v96, v80, v81
    v_cvt_pk_bf16_f32 v97, v82, v83
    v_cvt_pk_bf16_f32 v98, v84, v85
    v_cvt_pk_bf16_f32 v99, v86, v87
    v_cvt_pk_bf16_f32 v100, v88, v89
    v_cvt_pk_bf16_f32 v101, v90, v91
    v_cvt_pk_bf16_f32 v102, v92, v93
    v_cvt_pk_bf16_f32 v103, v94, v95
    buffer_store_dwordx4 v[96:99], v14, s[12:15], s53 offen sc1
    buffer_store_dwordx4 v[100:103], v14, s[12:15], s54 offen sc1
    v_mul_f32 v108, v8, v108
    v_mul_f32 v109, v8, v109
    v_mul_f32 v110, v8, v110
    v_mul_f32 v111, v8, v111
    v_mul_f32 v112, v8, v112
    v_mul_f32 v113, v8, v113
    v_mul_f32 v114, v8, v114
    v_mul_f32 v115, v8, v115
    v_mul_f32 v116, v8, v116
    v_mul_f32 v117, v8, v117
    v_mul_f32 v118, v8, v118
    v_mul_f32 v119, v8, v119
    v_mul_f32 v120, v8, v120
    v_mul_f32 v121, v8, v121
    v_mul_f32 v122, v8, v122
    v_mul_f32 v123, v8, v123
    v_cvt_pk_bf16_f32 v16, v108, v109
    v_cvt_pk_bf16_f32 v17, v110, v111
    v_cvt_pk_bf16_f32 v18, v112, v113
    v_cvt_pk_bf16_f32 v19, v114, v115
    v_cvt_pk_bf16_f32 v20, v116, v117
    v_cvt_pk_bf16_f32 v21, v118, v119
    v_cvt_pk_bf16_f32 v22, v120, v121
    v_cvt_pk_bf16_f32 v23, v122, v123
    buffer_store_dwordx4 v[16:19], v11, s[12:15], s88 offen sc1
    buffer_store_dwordx4 v[20:23], v11, s[12:15], s89 offen sc1
    s_branch L_KVE
L_VPRE:
    v_lshl_add_u32 v6, v8, 3, v6
    s_cmp_eq_u32 s3, 7
    s_cbranch_scc0 L_VP3
    v_mov_b32 v100, s20
    v_mov_b32 v101, s46
    s_lshl_b32 s23, s16, 5
    s_add_u32 s23, s23, s17
    s_lshl_b32 s23, s23, 3
    s_add_u32 s23, s23, 4096
    s_mov_b64 exec, 1
    buffer_store_dwordx2 v[100:101], off, s[12:15], s23 sc1
    s_mov_b64 exec, -1
L_VP3:
    v_bfe_u32 v14, v1, 4, 1
    v_lshlrev_b32 v14, 17, v14
    v_lshrrev_b32 v9, 5, v1
    v_lshl_add_u32 v14, v9, 9, v14
    v_and_b32 v9, 15, v1
    v_lshl_add_u32 v14, v9, 4, v14
    s_add_u32 s53, s50, 2098176
    s_add_u32 s54, s53, 256
    s_mov_b32 s40, s59
    s_mov_b32 s41, s60
    s_mov_b32 s58, 0
    s_mov_b32 s56, 73728
L_V:
    v_add_u32 v7, s56, v6
    s_barrier
    ds_read_b128 v[16:19], v2 offset:0
    ds_read_b64_tr_b16 v[32:33], v7 offset:0
    ds_read_b64_tr_b16 v[34:35], v7 offset:512
    ds_read_b128 v[20:23], v3 offset:0
    ds_read_b64_tr_b16 v[36:37], v7 offset:2048
    ds_read_b64_tr_b16 v[38:39], v7 offset:2560
    ds_read_b128 v[24:27], v4 offset:0
    ds_read_b64_tr_b16 v[40:41], v7 offset:4096
    ds_read_b64_tr_b16 v[42:43], v7 offset:4608
    ds_read_b128 v[28:31], v5 offset:0
    ds_read_b64_tr_b16 v[44:45], v7 offset:6144
    ds_read_b64_tr_b16 v[46:47], v7 offset:6656
    s_add_u32 s56, s56, 24576
    s_cmp_ge_u32 s56, 163840
    s_cselect_b32 s23, 98304, 0
    s_sub_u32 s56, s56, s23
    v_add_u32 v2, 8192, v2
    v_add_u32 v3, 8192, v3
    v_add_u32 v4, 8192, v4
    v_add_u32 v5, 8192, v5
    s_add_u32 s58, s58, 1
    s_cmp_eq_u32 s58, 8
    s_waitcnt lgkmcnt(9)
    v_mfma_f32_32x32x16_bf16 v[80:95], v[16:19], v[32:35], v[80:95]
    s_waitcnt lgkmcnt(6)
    v_mfma_f32_32x32x16_bf16 v[80:95], v[20:23], v[36:39], v[80:95]
    s_waitcnt lgkmcnt(3)
    v_mfma_f32_32x32x16_bf16 v[80:95], v[24:27], v[40:43], v[80:95]
    s_waitcnt lgkmcnt(0)
    s_cbranch_scc1 L_Ve
    v_mfma_f32_32x32x16_bf16 v[80:95], v[28:31], v[44:47], v[80:95]
    s_branch L_V
L_Ve:
    s_barrier
    v_mfma_f32_32x32x16_bf16 v[80:95], v[28:31], v[44:47], v[80:95]
    v_and_b32 v9, 31, v1
    v_lshlrev_b32 v9, 3, v9
    s_lshl_b32 s23, s16, 8
    s_add_u32 s23, s23, 4096
    buffer_load_dwordx2 v[12:13], v9, s[12:15], s23 offen sc1
    s_nop 6
    v_cvt_pk_bf16_f32 v96, v80, v81
    v_cvt_pk_bf16_f32 v97, v82, v83
    v_cvt_pk_bf16_f32 v98, v84, v85
    v_cvt_pk_bf16_f32 v99, v86, v87
    v_cvt_pk_bf16_f32 v100, v88, v89
    v_cvt_pk_bf16_f32 v101, v90, v91
    v_cvt_pk_bf16_f32 v102, v92, v93
    v_cvt_pk_bf16_f32 v103, v94, v95
    buffer_store_dwordx4 v[96:99], v14, s[12:15], s53 offen sc1
    buffer_store_dwordx4 v[100:103], v14, s[12:15], s54 offen sc1
L_KVE:
    s_lshr_b32 s52, s3, 1
    s_sub_u32 s63, s62, s30
    s_lshr_b32 s23, s3, 2
    s_lshl_b32 s23, s23, 13
    v_add_u32 v2, s23, v11
    v_mov_b32 v28, 156676
    v_mov_b32 v147, 156672
    v_mov_b32 v160, v10
    s_lshl_b32 s23, s34, 5
    s_add_u32 s23, s23, s17
    s_lshl_b32 s88, s23, 10
    s_add_u32 s88, s88, 12582912
    s_lshl_b32 s89, s23, 2
    s_add_u32 s89, s89, 40960
    s_lshl_b32 s23, s16, 2
    s_add_u32 s24, s23, s18
    s_lshl_b32 s23, s24, 1
    s_add_u32 s23, s23, s48
    s_lshl_b32 s23, s23, 2
    s_add_u32 s23, s23, s52
    s_lshl_b32 s90, s23, 13
    s_add_u32 s90, s90, 12582912
    s_add_u32 s91, s90, 4096
    s_lshl_b32 s92, s23, 5
    s_add_u32 s92, s92, 40960
    s_lshl_b32 s23, s24, 3
    s_add_u32 s23, s23, s3
    s_lshl_b32 s23, s23, 15
    s_lshl_b32 s24, s19, 8
    s_add_u32 s23, s23, s24
    s_add_u32 s93, s23, 2048
    s_add_u32 s35, s93, 16384
    s_mov_b32 s36, s86
    s_mov_b32 s37, s87
    s_mov_b32 s38, 0x800000
    s_mov_b32 s39, 0x20000
    v_and_b32 v29, 7, v1
    v_lshlrev_b32 v155, 2, v29
    s_lshl_b32 s23, s52, 13
    v_add_u32 v156, s23, v11
    s_add_u32 s23, s30, 98304
    v_add_u32 v157, s23, v11
    s_lshl_b32 s23, s3, 8
    s_add_u32 s23, s23, 157696
    v_lshl_add_u32 v158, v1, 2, s23
    s_lshl_b32 s23, s3, 2
    s_add_u32 s23, s23, 156736
    v_mov_b32 v159, s23
    s_lshl_b32 s23, s3, 13
    v_and_b32 v30, 31, v1
    v_lshrrev_b32 v31, 5, v1
    v_xor_b32 v31, v31, v30
    v_and_b32 v31, 7, v31
    v_lshlrev_b32 v31, 4, v31
    v_lshl_add_u32 v30, v30, 7, v31
    v_add_u32 v148, s23, v30
    v_xor_b32 v149, 32, v148
    v_xor_b32 v150, 64, v148
    v_xor_b32 v151, 96, v148
    v_lshrrev_b32 v30, 4, v1
    v_xor_b32 v29, v29, v30
    v_lshlrev_b32 v29, 4, v29
    v_lshl_add_u32 v29, v30, 7, v29
    v_bfe_u32 v31, v1, 3, 1
    v_lshl_add_u32 v29, v31, 12, v29
    s_lshr_b32 s23, s3, 2
    s_lshl_b32 s23, s23, 13
    s_and_b32 s24, s3, 3
    s_lshl_b32 s24, s24, 10
    s_add_u32 s23, s23, s24
    v_add_u32 v152, s23, v29
    v_xor_b32 v153, 64, v152
    v_and_b32 v29, 15, v1
    v_lshlrev_b32 v29, 4, v29
    v_lshl_add_u32 v154, v30, 12, v29
    v_min_u32 v30, 11, v1
    v_lshlrev_b32 v30, 2, v30
    v_mov_b32 v64, 0
    v_mov_b32 v65, 0
    v_mov_b32 v66, 0
    v_mov_b32 v67, 0
    v_mov_b32 v68, 0
    v_mov_b32 v69, 0
    v_mov_b32 v70, 0
    v_mov_b32 v71, 0
    v_mov_b32 v72, 0
    v_mov_b32 v73, 0
    v_mov_b32 v74, 0
    v_mov_b32 v75, 0
    v_mov_b32 v76, 0
    v_mov_b32 v77, 0
    v_mov_b32 v78, 0
    v_mov_b32 v79, 0
    v_mov_b32 v80, 0
    v_mov_b32 v81, 0
    v_mov_b32 v82, 0
    v_mov_b32 v83, 0
    v_mov_b32 v84, 0
    v_mov_b32 v85, 0
    v_mov_b32 v86, 0
    v_mov_b32 v87, 0
    v_mov_b32 v88, 0
    v_mov_b32 v89, 0
    v_mov_b32 v90, 0
    v_mov_b32 v91, 0
    v_mov_b32 v92, 0
    v_mov_b32 v93, 0
    v_mov_b32 v94, 0
    v_mov_b32 v95, 0
    s_waitcnt vmcnt(0)
    s_lshr_b32 s23, s3, 2
    s_lshl_b32 s23, s23, 2
    v_add_u32 v29, s23, v147
    s_mov_b64 exec, 1
    ds_add_rtn_u32 v29, v29, v145 offset:104
    s_mov_b64 exec, -1
    v_cmp_eq_u32 s[24:25], s20, v12
    v_cmp_eq_u32 vcc, s46, v13
    s_nop 1
    s_and_b64 vcc, vcc, s[24:25]
    s_cmp_eq_u64 vcc, -1
    s_cselect_b32 s22, 1, 0
    s_cmp_eq_u32 s22, 0
    s_cselect_b32 s28, s31, s28
    v_add_u32 v30, s28, v30
    s_waitcnt lgkmcnt(0)
    v_readfirstlane_b32 s24, v29
    s_xor_b32 s23, s33, 1024
    s_cmp_eq_u32 s24, 3
    s_cbranch_scc0 L_KF
    s_mov_b64 exec, 1
    buffer_store_dword v10, off, s[12:15], s59
    buffer_store_dword v10, off, s[12:15], s40
    s_mov_b64 exec, -1
    buffer_load_dword v29, v30, s[12:15], 0 offen sc1
    s_mov_b64 exec, 1
    buffer_store_dword v10, off, s[12:15], s60 sc1
    buffer_store_dword v10, off, s[12:15], s41 sc1
    s_mov_b64 exec, -1
    s_waitcnt vmcnt(2)
    v_cmp_ne_u32 vcc, s20, v29
    s_nop 1
    s_cbranch_vccz L_KG
L_KF:
    s_mov_b32 s47, 0
L_poll42:
    buffer_load_dword v29, v30, s[12:15], 0 offen sc1
    s_add_u32 s47, s47, 1
    s_cmp_gt_u32 s47, 2097152
    s_cbranch_scc1 L_pd43
    s_waitcnt vmcnt(0)
    v_cmp_ne_u32 vcc, s20, v29
    s_nop 1
    s_cbranch_vccnz L_poll42
L_pd43:
L_KG:
    s_mov_b32 m0, s30
    s_nop 0
    buffer_load_dwordx4 v11, s[12:15], s29 offen sc1 lds
    buffer_load_dwordx4 v11, s[12:15], s29 offen offset:1024 sc1 lds
    buffer_load_dwordx4 v[4:7], v11, s[12:15], s33 offen sc1
    buffer_load_dwordx4 v[96:99], v11, s[12:15], s23 offen sc1
    v_and_b32 v29, 31, v1
    v_cmp_eq_u32 vcc, 16, v29
    v_mov_b32 v29, 0x3f803f80
    s_nop 0
    v_cndmask_b32 v12, 0, v29, vcc
    v_mov_b32 v13, v12
    v_mov_b32 v14, v12
    v_mov_b32 v15, v12
    v_mov_b32 v16, v12
    v_mov_b32 v17, v12
    v_mov_b32 v18, v12
    v_mov_b32 v19, v12
    v_mov_b32 v100, v12
    v_mov_b32 v101, v12
    v_mov_b32 v102, v12
    v_mov_b32 v103, v12
    v_mov_b32 v104, v12
    v_mov_b32 v105, v12
    v_mov_b32 v106, v12
    v_mov_b32 v107, v12
    s_cmp_ge_u32 s3, 4
    s_cbranch_scc0 L_PR
    s_setprio 1
L_PR:
    s_waitcnt vmcnt(0)
    s_barrier
    ds_read_b128 v[8:11], v2
    s_mov_b64 exec, s[44:45]
    ds_read_b128 v[12:15], v2 offset:1024
    ds_read_b128 v[16:19], v2 offset:1280
    s_mov_b64 exec, -1
    s_waitcnt lgkmcnt(0)
    v_mfma_f32_32x32x16_bf16 v[32:47], v[8:11], v[4:7], 0
    s_mov_b32 s58, 0
    s_nop 10
    v_exp_f32 v32, v32
    v_exp_f32 v33, v33
    s_cmp_ge_u32 s3, 4
    s_cbranch_scc1 L_Av
.p2align 6
L_Ak:
    s_setprio 2
    v_exp_f32 v34, v34
    v_exp_f32 v35, v35
    v_exp_f32 v36, v36
    v_exp_f32 v37, v37
    v_exp_f32 v38, v38
    v_exp_f32 v39, v39
    v_mfma_f32_32x32x16_bf16 v[48:63], v[8:11], v[96:99], 0
    ds_read_b128 v[8:11], v2 offset:2048
    s_mov_b64 exec, s[44:45]
    ds_read_b128 v[100:103], v2 offset:3072
    ds_read_b128 v[104:107], v2 offset:3328
    s_mov_b64 exec, -1
    v_cvt_pk_bf16_f32 v20, v32, v33
    v_cvt_pk_bf16_f32 v21, v34, v35
    v_cvt_pk_bf16_f32 v22, v36, v37
    v_cvt_pk_bf16_f32 v23, v38, v39
    v_exp_f32 v40, v40
    v_exp_f32 v41, v41
    v_mfma_f32_32x32x16_bf16 v[64:79], v[12:15], v[20:23], v[64:79]
    v_exp_f32 v42, v42
    v_exp_f32 v43, v43
    v_exp_f32 v44, v44
    v_exp_f32 v45, v45
    v_exp_f32 v46, v46
    v_exp_f32 v47, v47
    v_cvt_pk_bf16_f32 v24, v40, v41
    v_cvt_pk_bf16_f32 v25, v42, v43
    v_cvt_pk_bf16_f32 v26, v44, v45
    v_cvt_pk_bf16_f32 v27, v46, v47
    v_exp_f32 v48, v48
    v_exp_f32 v49, v49
    v_mfma_f32_32x32x16_bf16 v[64:79], v[16:19], v[24:27], v[64:79]
    v_exp_f32 v50, v50
    v_exp_f32 v51, v51
    v_exp_f32 v52, v52
    v_exp_f32 v53, v53
    v_exp_f32 v54, v54
    v_exp_f32 v55, v55
    s_waitcnt lgkmcnt(0)
    v_mfma_f32_32x32x16_bf16 v[32:47], v[8:11], v[4:7], 0
    v_cvt_pk_bf16_f32 v20, v48, v49
    v_cvt_pk_bf16_f32 v21, v50, v51
    v_cvt_pk_bf16_f32 v22, v52, v53
    v_cvt_pk_bf16_f32 v23, v54, v55
    v_exp_f32 v56, v56
    v_exp_f32 v57, v57
    v_mfma_f32_32x32x16_bf16 v[80:95], v[12:15], v[20:23], v[80:95]
    v_exp_f32 v58, v58
    v_exp_f32 v59, v59
    v_exp_f32 v60, v60
    v_exp_f32 v61, v61
    v_exp_f32 v62, v62
    v_exp_f32 v63, v63
    v_cvt_pk_bf16_f32 v24, v56, v57
    v_cvt_pk_bf16_f32 v25, v58, v59
    v_cvt_pk_bf16_f32 v26, v60, v61
    v_cvt_pk_bf16_f32 v27, v62, v63
    v_exp_f32 v32, v32
    v_exp_f32 v33, v33
    v_mfma_f32_32x32x16_bf16 v[80:95], v[16:19], v[24:27], v[80:95]
    s_mov_b64 exec, 1
    ds_add_u32 v28, v145 offset:124
    s_mov_b64 exec, -1
    v_exp_f32 v34, v34
    v_exp_f32 v35, v35
    v_exp_f32 v36, v36
    v_exp_f32 v37, v37
    v_exp_f32 v38, v38
    v_exp_f32 v39, v39
    v_mfma_f32_32x32x16_bf16 v[48:63], v[8:11], v[96:99], 0
    ds_read_b128 v[8:11], v2 offset:4096
    s_mov_b64 exec, s[44:45]
    ds_read_b128 v[12:15], v2 offset:5120
    ds_read_b128 v[16:19], v2 offset:5376
    s_mov_b64 exec, -1
    v_cvt_pk_bf16_f32 v20, v32, v33
    v_cvt_pk_bf16_f32 v21, v34, v35
    v_cvt_pk_bf16_f32 v22, v36, v37
    v_cvt_pk_bf16_f32 v23, v38, v39
    v_exp_f32 v40, v40
    v_exp_f32 v41, v41
    v_mfma_f32_32x32x16_bf16 v[64:79], v[100:103], v[20:23], v[64:79]
    v_exp_f32 v42, v42
    v_exp_f32 v43, v43
    v_exp_f32 v44, v44
    v_exp_f32 v45, v45
    v_exp_f32 v46, v46
    v_exp_f32 v47, v47
    v_cvt_pk_bf16_f32 v24, v40, v41
    v_cvt_pk_bf16_f32 v25, v42, v43
    v_cvt_pk_bf16_f32 v26, v44, v45
    v_cvt_pk_bf16_f32 v27, v46, v47
    v_exp_f32 v48, v48
    v_exp_f32 v49, v49
    v_mfma_f32_32x32x16_bf16 v[64:79], v[104:107], v[24:27], v[64:79]
    v_exp_f32 v50, v50
    v_exp_f32 v51, v51
    v_exp_f32 v52, v52
    v_exp_f32 v53, v53
    v_exp_f32 v54, v54
    v_exp_f32 v55, v55
    s_waitcnt lgkmcnt(0)
    v_mfma_f32_32x32x16_bf16 v[32:47], v[8:11], v[4:7], 0
    v_cvt_pk_bf16_f32 v20, v48, v49
    v_cvt_pk_bf16_f32 v21, v50, v51
    v_cvt_pk_bf16_f32 v22, v52, v53
    v_cvt_pk_bf16_f32 v23, v54, v55
    v_exp_f32 v56, v56
    v_exp_f32 v57, v57
    v_mfma_f32_32x32x16_bf16 v[80:95], v[100:103], v[20:23], v[80:95]
    v_exp_f32 v58, v58
    v_exp_f32 v59, v59
    v_exp_f32 v60, v60
    v_exp_f32 v61, v61
    v_exp_f32 v62, v62
    v_exp_f32 v63, v63
    v_cvt_pk_bf16_f32 v24, v56, v57
    v_cvt_pk_bf16_f32 v25, v58, v59
    v_cvt_pk_bf16_f32 v26, v60, v61
    v_cvt_pk_bf16_f32 v27, v62, v63
    v_exp_f32 v32, v32
    v_exp_f32 v33, v33
    v_mfma_f32_32x32x16_bf16 v[80:95], v[104:107], v[24:27], v[80:95]
    v_exp_f32 v34, v34
    v_exp_f32 v35, v35
    v_exp_f32 v36, v36
    v_exp_f32 v37, v37
    v_exp_f32 v38, v38
    v_exp_f32 v39, v39
    v_mfma_f32_32x32x16_bf16 v[48:63], v[8:11], v[96:99], 0
    ds_read_b128 v[8:11], v2 offset:6144
    ds_read_b32 v3, v28
    s_mov_b64 exec, s[44:45]
    ds_read_b128 v[100:103], v2 offset:7168
    ds_read_b128 v[104:107], v2 offset:7424
    s_mov_b64 exec, -1
    v_cvt_pk_bf16_f32 v20, v32, v33
    v_cvt_pk_bf16_f32 v21, v34, v35
    v_cvt_pk_bf16_f32 v22, v36, v37
    v_cvt_pk_bf16_f32 v23, v38, v39
    v_exp_f32 v40, v40
    v_exp_f32 v41, v41
    v_mfma_f32_32x32x16_bf16 v[64:79], v[12:15], v[20:23], v[64:79]
    v_exp_f32 v42, v42
    v_exp_f32 v43, v43
    v_exp_f32 v44, v44
    v_exp_f32 v45, v45
    v_exp_f32 v46, v46
    v_exp_f32 v47, v47
    v_cvt_pk_bf16_f32 v24, v40, v41
    v_cvt_pk_bf16_f32 v25, v42, v43
    v_cvt_pk_bf16_f32 v26, v44, v45
    v_cvt_pk_bf16_f32 v27, v46, v47
    v_exp_f32 v48, v48
    v_exp_f32 v49, v49
    v_mfma_f32_32x32x16_bf16 v[64:79], v[16:19], v[24:27], v[64:79]
    v_exp_f32 v50, v50
    v_exp_f32 v51, v51
    v_exp_f32 v52, v52
    v_exp_f32 v53, v53
    v_exp_f32 v54, v54
    v_exp_f32 v55, v55
    s_waitcnt lgkmcnt(0)
    v_mfma_f32_32x32x16_bf16 v[32:47], v[8:11], v[4:7], 0
    v_cvt_pk_bf16_f32 v20, v48, v49
    v_cvt_pk_bf16_f32 v21, v50, v51
    v_cvt_pk_bf16_f32 v22, v52, v53
    v_cvt_pk_bf16_f32 v23, v54, v55
    v_exp_f32 v56, v56
    v_exp_f32 v57, v57
    v_mfma_f32_32x32x16_bf16 v[80:95], v[12:15], v[20:23], v[80:95]
    v_exp_f32 v58, v58
    v_exp_f32 v59, v59
    v_exp_f32 v60, v60
    v_exp_f32 v61, v61
    v_exp_f32 v62, v62
    v_exp_f32 v63, v63
    v_cvt_pk_bf16_f32 v24, v56, v57
    v_cvt_pk_bf16_f32 v25, v58, v59
    v_cvt_pk_bf16_f32 v26, v60, v61
    v_cvt_pk_bf16_f32 v27, v62, v63
    v_exp_f32 v32, v32
    v_exp_f32 v33, v33
    v_mfma_f32_32x32x16_bf16 v[80:95], v[16:19], v[24:27], v[80:95]
    v_readfirstlane_b32 s23, v3
    v_exp_f32 v34, v34
    v_exp_f32 v35, v35
    v_exp_f32 v36, v36
    v_exp_f32 v37, v37
    v_exp_f32 v38, v38
    v_exp_f32 v39, v39
    v_mfma_f32_32x32x16_bf16 v[48:63], v[8:11], v[96:99], 0
    s_cmp_lt_u32 s23, 12
    s_cbranch_scc1 L_AWk
L_ARk:
    ds_read_b128 v[8:11], v2 offset:16384
    s_mov_b64 exec, s[44:45]
    ds_read_b128 v[12:15], v2 offset:17408
    ds_read_b128 v[16:19], v2 offset:17664
    s_mov_b64 exec, -1
    v_cvt_pk_bf16_f32 v20, v32, v33
    v_cvt_pk_bf16_f32 v21, v34, v35
    v_cvt_pk_bf16_f32 v22, v36, v37
    v_cvt_pk_bf16_f32 v23, v38, v39
    v_exp_f32 v40, v40
    v_exp_f32 v41, v41
    v_mfma_f32_32x32x16_bf16 v[64:79], v[100:103], v[20:23], v[64:79]
    v_exp_f32 v42, v42
    v_exp_f32 v43, v43
    v_exp_f32 v44, v44
    v_exp_f32 v45, v45
    v_exp_f32 v46, v46
    v_exp_f32 v47, v47
    s_setprio 0
    v_cvt_pk_bf16_f32 v24, v40, v41
    v_cvt_pk_bf16_f32 v25, v42, v43
    v_cvt_pk_bf16_f32 v26, v44, v45
    v_cvt_pk_bf16_f32 v27, v46, v47
    v_exp_f32 v48, v48
    v_exp_f32 v49, v49
    v_mfma_f32_32x32x16_bf16 v[64:79], v[104:107], v[24:27], v[64:79]
    v_exp_f32 v50, v50
    v_exp_f32 v51, v51
    v_exp_f32 v52, v52
    v_exp_f32 v53, v53
    v_exp_f32 v54, v54
    v_exp_f32 v55, v55
    s_waitcnt lgkmcnt(0)
    v_mfma_f32_32x32x16_bf16 v[32:47], v[8:11], v[4:7], 0
    v_cvt_pk_bf16_f32 v20, v48, v49
    v_cvt_pk_bf16_f32 v21, v50, v51
    v_cvt_pk_bf16_f32 v22, v52, v53
    v_cvt_pk_bf16_f32 v23, v54, v55
    v_exp_f32 v56, v56
    v_exp_f32 v57, v57
    v_mfma_f32_32x32x16_bf16 v[80:95], v[100:103], v[20:23], v[80:95]
    v_exp_f32 v58, v58
    v_exp_f32 v59, v59
    v_exp_f32 v60, v60
    v_exp_f32 v61, v61
    v_exp_f32 v62, v62
    v_exp_f32 v63, v63
    v_cvt_pk_bf16_f32 v24, v56, v57
    v_cvt_pk_bf16_f32 v25, v58, v59
    v_cvt_pk_bf16_f32 v26, v60, v61
    v_cvt_pk_bf16_f32 v27, v62, v63
    v_exp_f32 v32, v32
    v_exp_f32 v33, v33
    v_mfma_f32_32x32x16_bf16 v[80:95], v[104:107], v[24:27], v[80:95]
    v_add_u32 v2, 16384, v2
    v_add_u32 v28, 4, v28
    s_add_u32 s58, s58, 1
    s_cmp_lt_u32 s58, 8
    s_cbranch_scc1 L_Ak
    s_branch L_AE
.p2align 6
L_Av:
    v_exp_f32 v34, v34
    v_exp_f32 v35, v35
    v_exp_f32 v36, v36
    v_exp_f32 v37, v37
    v_exp_f32 v38, v38
    v_exp_f32 v39, v39
    v_mfma_f32_32x32x16_bf16 v[48:63], v[8:11], v[96:99], 0
    ds_read_b128 v[8:11], v2 offset:2048
    s_mov_b64 exec, s[44:45]
    ds_read_b128 v[100:103], v2 offset:3072
    ds_read_b128 v[104:107], v2 offset:3328
    s_mov_b64 exec, -1
    v_cvt_pk_bf16_f32 v20, v32, v33
    v_cvt_pk_bf16_f32 v21, v34, v35
    v_cvt_pk_bf16_f32 v22, v36, v37
    v_cvt_pk_bf16_f32 v23, v38, v39
    v_exp_f32 v40, v40
    v_exp_f32 v41, v41
    v_mfma_f32_32x32x16_bf16 v[64:79], v[12:15], v[20:23], v[64:79]
    v_exp_f32 v42, v42
    v_exp_f32 v43, v43
    v_exp_f32 v44, v44
    v_exp_f32 v45, v45
    v_exp_f32 v46, v46
    v_exp_f32 v47, v47
    v_cvt_pk_bf16_f32 v24, v40, v41
    v_cvt_pk_bf16_f32 v25, v42, v43
    v_cvt_pk_bf16_f32 v26, v44, v45
    v_cvt_pk_bf16_f32 v27, v46, v47
    v_exp_f32 v48, v48
    v_exp_f32 v49, v49
    v_mfma_f32_32x32x16_bf16 v[64:79], v[16:19], v[24:27], v[64:79]
    v_exp_f32 v50, v50
    v_exp_f32 v51, v51
    v_exp_f32 v52, v52
    v_exp_f32 v53, v53
    v_exp_f32 v54, v54
    v_exp_f32 v55, v55
    s_waitcnt lgkmcnt(0)
    v_mfma_f32_32x32x16_bf16 v[32:47], v[8:11], v[4:7], 0
    v_cvt_pk_bf16_f32 v20, v48, v49
    v_cvt_pk_bf16_f32 v21, v50, v51
    v_cvt_pk_bf16_f32 v22, v52, v53
    v_cvt_pk_bf16_f32 v23, v54, v55
    v_exp_f32 v56, v56
    v_exp_f32 v57, v57
    v_mfma_f32_32x32x16_bf16 v[80:95], v[12:15], v[20:23], v[80:95]
    v_exp_f32 v58, v58
    v_exp_f32 v59, v59
    v_exp_f32 v60, v60
    v_exp_f32 v61, v61
    v_exp_f32 v62, v62
    v_exp_f32 v63, v63
    v_cvt_pk_bf16_f32 v24, v56, v57
    v_cvt_pk_bf16_f32 v25, v58, v59
    v_cvt_pk_bf16_f32 v26, v60, v61
    v_cvt_pk_bf16_f32 v27, v62, v63
    v_exp_f32 v32, v32
    v_exp_f32 v33, v33
    v_mfma_f32_32x32x16_bf16 v[80:95], v[16:19], v[24:27], v[80:95]
    s_mov_b64 exec, 1
    ds_add_u32 v28, v145 offset:124
    s_mov_b64 exec, -1
    v_exp_f32 v34, v34
    v_exp_f32 v35, v35
    v_exp_f32 v36, v36
    v_exp_f32 v37, v37
    v_exp_f32 v38, v38
    v_exp_f32 v39, v39
    v_mfma_f32_32x32x16_bf16 v[48:63], v[8:11], v[96:99], 0
    ds_read_b128 v[8:11], v2 offset:4096
    s_mov_b64 exec, s[44:45]
    ds_read_b128 v[12:15], v2 offset:5120
    ds_read_b128 v[16:19], v2 offset:5376
    s_mov_b64 exec, -1
    v_cvt_pk_bf16_f32 v20, v32, v33
    v_cvt_pk_bf16_f32 v21, v34, v35
    v_cvt_pk_bf16_f32 v22, v36, v37
    v_cvt_pk_bf16_f32 v23, v38, v39
    v_exp_f32 v40, v40
    v_exp_f32 v41, v41
    v_mfma_f32_32x32x16_bf16 v[64:79], v[100:103], v[20:23], v[64:79]
    v_exp_f32 v42, v42
    v_exp_f32 v43, v43
    v_exp_f32 v44, v44
    v_exp_f32 v45, v45
    v_exp_f32 v46, v46
    v_exp_f32 v47, v47
    v_cvt_pk_bf16_f32 v24, v40, v41
    v_cvt_pk_bf16_f32 v25, v42, v43
    v_cvt_pk_bf16_f32 v26, v44, v45
    v_cvt_pk_bf16_f32 v27, v46, v47
    v_exp_f32 v48, v48
    v_exp_f32 v49, v49
    v_mfma_f32_32x32x16_bf16 v[64:79], v[104:107], v[24:27], v[64:79]
    v_exp_f32 v50, v50
    v_exp_f32 v51, v51
    v_exp_f32 v52, v52
    v_exp_f32 v53, v53
    v_exp_f32 v54, v54
    v_exp_f32 v55, v55
    s_waitcnt lgkmcnt(0)
    v_mfma_f32_32x32x16_bf16 v[32:47], v[8:11], v[4:7], 0
    v_cvt_pk_bf16_f32 v20, v48, v49
    v_cvt_pk_bf16_f32 v21, v50, v51
    v_cvt_pk_bf16_f32 v22, v52, v53
    v_cvt_pk_bf16_f32 v23, v54, v55
    v_exp_f32 v56, v56
    v_exp_f32 v57, v57
    v_mfma_f32_32x32x16_bf16 v[80:95], v[100:103], v[20:23], v[80:95]
    v_exp_f32 v58, v58
    v_exp_f32 v59, v59
    v_exp_f32 v60, v60
    v_exp_f32 v61, v61
    v_exp_f32 v62, v62
    v_exp_f32 v63, v63
    v_cvt_pk_bf16_f32 v24, v56, v57
    v_cvt_pk_bf16_f32 v25, v58, v59
    v_cvt_pk_bf16_f32 v26, v60, v61
    v_cvt_pk_bf16_f32 v27, v62, v63
    v_exp_f32 v32, v32
    v_exp_f32 v33, v33
    v_mfma_f32_32x32x16_bf16 v[80:95], v[104:107], v[24:27], v[80:95]
    v_exp_f32 v34, v34
    v_exp_f32 v35, v35
    v_exp_f32 v36, v36
    v_exp_f32 v37, v37
    v_exp_f32 v38, v38
    v_exp_f32 v39, v39
    v_mfma_f32_32x32x16_bf16 v[48:63], v[8:11], v[96:99], 0
    ds_read_b128 v[8:11], v2 offset:6144
    ds_read_b32 v3, v28
    s_mov_b64 exec, s[44:45]
    ds_read_b128 v[100:103], v2 offset:7168
    ds_read_b128 v[104:107], v2 offset:7424
    s_mov_b64 exec, -1
    v_cvt_pk_bf16_f32 v20, v32, v33
    v_cvt_pk_bf16_f32 v21, v34, v35
    v_cvt_pk_bf16_f32 v22, v36, v37
    v_cvt_pk_bf16_f32 v23, v38, v39
    v_exp_f32 v40, v40
    v_exp_f32 v41, v41
    v_mfma_f32_32x32x16_bf16 v[64:79], v[12:15], v[20:23], v[64:79]
    v_exp_f32 v42, v42
    v_exp_f32 v43, v43
    v_exp_f32 v44, v44
    v_exp_f32 v45, v45
    v_exp_f32 v46, v46
    v_exp_f32 v47, v47
    v_cvt_pk_bf16_f32 v24, v40, v41
    v_cvt_pk_bf16_f32 v25, v42, v43
    v_cvt_pk_bf16_f32 v26, v44, v45
    v_cvt_pk_bf16_f32 v27, v46, v47
    v_exp_f32 v48, v48
    v_exp_f32 v49, v49
    v_mfma_f32_32x32x16_bf16 v[64:79], v[16:19], v[24:27], v[64:79]
    v_exp_f32 v50, v50
    v_exp_f32 v51, v51
    v_exp_f32 v52, v52
    v_exp_f32 v53, v53
    v_exp_f32 v54, v54
    v_exp_f32 v55, v55
    s_waitcnt lgkmcnt(0)
    v_mfma_f32_32x32x16_bf16 v[32:47], v[8:11], v[4:7], 0
    v_cvt_pk_bf16_f32 v20, v48, v49
    v_cvt_pk_bf16_f32 v21, v50, v51
    v_cvt_pk_bf16_f32 v22, v52, v53
    v_cvt_pk_bf16_f32 v23, v54, v55
    v_exp_f32 v56, v56
    v_exp_f32 v57, v57
    v_mfma_f32_32x32x16_bf16 v[80:95], v[12:15], v[20:23], v[80:95]
    v_exp_f32 v58, v58
    v_exp_f32 v59, v59
    v_exp_f32 v60, v60
    v_exp_f32 v61, v61
    v_exp_f32 v62, v62
    v_exp_f32 v63, v63
    v_cvt_pk_bf16_f32 v24, v56, v57
    v_cvt_pk_bf16_f32 v25, v58, v59
    v_cvt_pk_bf16_f32 v26, v60, v61
    v_cvt_pk_bf16_f32 v27, v62, v63
    v_exp_f32 v32, v32
    v_exp_f32 v33, v33
    v_mfma_f32_32x32x16_bf16 v[80:95], v[16:19], v[24:27], v[80:95]
    v_readfirstlane_b32 s23, v3
    v_exp_f32 v34, v34
    v_exp_f32 v35, v35
    v_exp_f32 v36, v36
    v_exp_f32 v37, v37
    v_exp_f32 v38, v38
    v_exp_f32 v39, v39
    v_mfma_f32_32x32x16_bf16 v[48:63], v[8:11], v[96:99], 0
    s_cmp_lt_u32 s23, 12
    s_cbranch_scc1 L_AWv
L_ARv:
    ds_read_b128 v[8:11], v2 offset:16384
    s_mov_b64 exec, s[44:45]
    ds_read_b128 v[12:15], v2 offset:17408
    ds_read_b128 v[16:19], v2 offset:17664
    s_mov_b64 exec, -1
    v_cvt_pk_bf16_f32 v20, v32, v33
    v_cvt_pk_bf16_f32 v21, v34, v35
    v_cvt_pk_bf16_f32 v22, v36, v37
    v_cvt_pk_bf16_f32 v23, v38, v39
    v_exp_f32 v40, v40
    v_exp_f32 v41, v41
    v_mfma_f32_32x32x16_bf16 v[64:79], v[100:103], v[20:23], v[64:79]
    v_exp_f32 v42, v42
    v_exp_f32 v43, v43
    v_exp_f32 v44, v44
    v_exp_f32 v45, v45
    v_exp_f32 v46, v46
    v_exp_f32 v47, v47
    v_cvt_pk_bf16_f32 v24, v40, v41
    v_cvt_pk_bf16_f32 v25, v42, v43
    v_cvt_pk_bf16_f32 v26, v44, v45
    v_cvt_pk_bf16_f32 v27, v46, v47
    v_exp_f32 v48, v48
    v_exp_f32 v49, v49
    v_mfma_f32_32x32x16_bf16 v[64:79], v[104:107], v[24:27], v[64:79]
    v_exp_f32 v50, v50
    v_exp_f32 v51, v51
    v_exp_f32 v52, v52
    v_exp_f32 v53, v53
    v_exp_f32 v54, v54
    v_exp_f32 v55, v55
    s_waitcnt lgkmcnt(0)
    v_mfma_f32_32x32x16_bf16 v[32:47], v[8:11], v[4:7], 0
    v_cvt_pk_bf16_f32 v20, v48, v49
    v_cvt_pk_bf16_f32 v21, v50, v51
    v_cvt_pk_bf16_f32 v22, v52, v53
    v_cvt_pk_bf16_f32 v23, v54, v55
    v_exp_f32 v56, v56
    v_exp_f32 v57, v57
    v_mfma_f32_32x32x16_bf16 v[80:95], v[100:103], v[20:23], v[80:95]
    v_exp_f32 v58, v58
    v_exp_f32 v59, v59
    v_exp_f32 v60, v60
    v_exp_f32 v61, v61
    v_exp_f32 v62, v62
    v_exp_f32 v63, v63
    v_cvt_pk_bf16_f32 v24, v56, v57
    v_cvt_pk_bf16_f32 v25, v58, v59
    v_cvt_pk_bf16_f32 v26, v60, v61
    v_cvt_pk_bf16_f32 v27, v62, v63
    v_exp_f32 v32, v32
    v_exp_f32 v33, v33
    v_mfma_f32_32x32x16_bf16 v[80:95], v[104:107], v[24:27], v[80:95]
    v_add_u32 v2, 16384, v2
    v_add_u32 v28, 4, v28
    s_add_u32 s58, s58, 1
    s_cmp_lt_u32 s58, 8
    s_cbranch_scc1 L_Av
L_AE:
    s_mov_b32 s47, 0
L_cw44:
    ds_read_b32 v146, v147 offset:156
    s_add_u32 s47, s47, 1
    s_cmp_gt_u32 s47, 2097152
    s_cbranch_scc1 L_cd45
    s_waitcnt lgkmcnt(0)
    v_cmp_gt_u32 vcc, 8, v146
    s_nop 1
    s_cbranch_vccnz L_cw44
L_cd45:
    s_setprio 2
    v_xor_b32 v8, 8192, v157
    v_xor_b32 v9, 1024, v158
    v_xor_b32 v10, 16, v159
    s_mov_b32 s23, 0x33800000
    s_mov_b32 s24, 0x53800000
    s_mov_b32 s25, 0x7f800000
    s_nop 0
    ds_write_b128 v157, v[80:83]
    ds_write_b128 v157, v[84:87] offset:1024
    ds_write_b32 v158, v88
    s_mov_b64 exec, 1
    ds_add_u32 v159, v145
    s_mov_b64 exec, -1
    ds_read_b32 v146, v10
    ds_read_b128 v[32:35], v8
    ds_read_b128 v[36:39], v8 offset:1024
    ds_read_b32 v40, v9
    s_waitcnt lgkmcnt(0)
    v_cmp_eq_u32 vcc, 0, v146
    s_nop 1
    s_cbranch_vccz L_XQ
    s_setprio 0
    s_mov_b32 s47, 0
L_cw46:
    ds_read_b32 v146, v10 offset:0
    s_add_u32 s47, s47, 1
    s_cmp_gt_u32 s47, 2097152
    s_cbranch_scc1 L_cd47
    s_waitcnt lgkmcnt(0)
    v_cmp_gt_u32 vcc, 1, v146
    s_nop 1
    s_cbranch_vccnz L_cw46
L_cd47:
    s_setprio 2
    ds_read_b128 v[32:35], v8
    ds_read_b128 v[36:39], v8 offset:1024
    ds_read_b32 v40, v9
    s_waitcnt lgkmcnt(0)
L_XQ:
    v_add_f32 v72, v72, v40
    v_pk_add_f32 v[64:65], v[64:65], v[32:33]
    v_pk_add_f32 v[66:67], v[66:67], v[34:35]
    v_pk_add_f32 v[68:69], v[68:69], v[36:37]
    v_pk_add_f32 v[70:71], v[70:71], v[38:39]
    v_mov_b32 v30, v72
    s_nop 1
    v_permlane32_swap_b32 v72, v30
    s_mov_b32 s58, 0
L_FBR:
    v_rcp_f32 v30, v72
    s_nop 0
    v_pk_mul_f32 v[32:33], v[64:65], v[30:31] op_sel_hi:[1,0]
    v_pk_mul_f32 v[34:35], v[66:67], v[30:31] op_sel_hi:[1,0]
    v_pk_mul_f32 v[36:37], v[68:69], v[30:31] op_sel_hi:[1,0]
    v_pk_mul_f32 v[38:39], v[70:71], v[30:31] op_sel_hi:[1,0]
    v_cvt_pk_bf16_f32 v8, v32, v33
    v_cvt_pk_bf16_f32 v9, v34, v35
    v_cvt_pk_bf16_f32 v10, v36, v37
    v_cvt_pk_bf16_f32 v11, v38, v39
    buffer_store_dwordx4 v[8:11], v144, s[12:15], s88 offen sc1
    buffer_load_dword v161, v155, s[12:15], s92 offen sc1
    s_cmp_lg_u32 s58, 0
    s_cbranch_scc1 L_OK
    v_max3_f32 v44, |v64|, |v65|, |v66|
    v_max3_f32 v45, |v67|, |v68|, |v69|
    v_max3_f32 v44, |v70|, |v71|, v44
    v_cmp_le_f32 s[26:27], s23, v72
    v_cmp_ge_f32 s[28:29], s24, v72
    v_max_f32 v44, v44, v45
    v_add_f32 v45, v64, v65
    v_add_f32 v46, v66, v67
    v_add_f32 v47, v68, v69
    v_add_f32 v43, v70, v71
    v_add_f32 v45, v45, v46
    v_add_f32 v47, v47, v43
    v_cmp_gt_f32 s[30:31], s25, v44
    v_cmp_o_f32 vcc, v45, v47
    s_and_b64 s[26:27], s[26:27], s[28:29]
    s_and_b64 s[30:31], s[30:31], vcc
    s_and_b64 s[26:27], s[26:27], s[30:31]
    s_cmp_eq_u64 s[26:27], -1
    s_cbranch_scc0 L_FB
L_OK:
    s_waitcnt vmcnt(1)
    s_mov_b64 exec, 1
    s_cmp_eq_u32 s22, 0
    s_cbranch_scc1 L_safe48
    buffer_store_dword v160, off, s[12:15], s89
    s_branch L_done49
L_safe48:
    buffer_store_dword v160, off, s[12:15], s89 sc1
L_done49:
    s_mov_b64 exec, -1
    s_mov_b32 s47, 0
L_cw50:
    ds_read_b32 v146, v147 offset:36
    s_add_u32 s47, s47, 1
    s_cmp_gt_u32 s47, 2097152
    s_cbranch_scc1 L_cd51
    s_waitcnt lgkmcnt(0)
    v_cmp_gt_u32 vcc, 4, v146
    s_nop 1
    s_cbranch_vccnz L_cw50
L_cd51:
    ds_read_b128 v[80:83], v156 offset:0
    ds_read_b128 v[112:115], v156 offset:32768
    ds_read_b128 v[84:87], v156 offset:1024
    ds_read_b128 v[116:119], v156 offset:33792
    ds_read_b128 v[88:91], v156 offset:2048
    ds_read_b128 v[120:123], v156 offset:34816
    ds_read_b128 v[92:95], v156 offset:3072
    ds_read_b128 v[124:127], v156 offset:35840
    ds_read_b128 v[96:99], v156 offset:4096
    ds_read_b128 v[128:131], v156 offset:36864
    ds_read_b128 v[100:103], v156 offset:5120
    ds_read_b128 v[132:135], v156 offset:37888
    s_waitcnt lgkmcnt(8)
    ds_read_b128 v[104:107], v156 offset:6144
    ds_read_b128 v[136:139], v156 offset:38912
    ds_read_b128 v[108:111], v156 offset:7168
    ds_read_b128 v[140:143], v156 offset:39936
    s_mov_b64 exec, 1
    ds_add_u32 v147, v145 offset:56
    s_mov_b64 exec, -1
    s_waitcnt vmcnt(1)
    v_cmp_ne_u32 vcc, s20, v161
    s_nop 1
    s_cbranch_vccz L_OR
    s_mov_b32 s47, 0
L_poll52:
    buffer_load_dword v161, v155, s[12:15], s92 offen sc1
    s_add_u32 s47, s47, 1
    s_cmp_gt_u32 s47, 2097152
    s_cbranch_scc1 L_pd53
    s_waitcnt vmcnt(0)
    v_cmp_ne_u32 vcc, s20, v161
    s_nop 1
    s_cbranch_vccnz L_poll52
L_pd53:
L_OR:
    buffer_load_dwordx4 v[16:19], v144, s[12:15], s90 offen offset:0 sc1
    buffer_load_dwordx4 v[20:23], v144, s[12:15], s90 offen offset:1024 sc1
    buffer_load_dwordx4 v[24:27], v144, s[12:15], s90 offen offset:2048 sc1
    buffer_load_dwordx4 v[28:31], v144, s[12:15], s90 offen offset:3072 sc1
    buffer_load_dwordx4 v[32:35], v144, s[12:15], s91 offen offset:0 sc1
    buffer_load_dwordx4 v[36:39], v144, s[12:15], s91 offen offset:1024 sc1
    buffer_load_dwordx4 v[40:43], v144, s[12:15], s91 offen offset:2048 sc1
    buffer_load_dwordx4 v[44:47], v144, s[12:15], s91 offen offset:3072 sc1
    s_mov_b32 s47, 0
L_cw54:
    ds_read_b32 v146, v147 offset:56
    s_add_u32 s47, s47, 1
    s_cmp_gt_u32 s47, 2097152
    s_cbranch_scc1 L_cd55
    s_waitcnt lgkmcnt(0)
    v_cmp_gt_u32 vcc, 8, v146
    s_nop 1
    s_cbranch_vccnz L_cw54
L_cd55:
    s_waitcnt vmcnt(7)
    v_mfma_f32_32x32x16_bf16 v[48:63], v[80:83], v[16:19], 0
    v_mfma_f32_32x32x16_bf16 v[64:79], v[112:115], v[16:19], 0
    s_waitcnt vmcnt(6)
    v_mfma_f32_32x32x16_bf16 v[48:63], v[84:87], v[20:23], v[48:63]
    v_mfma_f32_32x32x16_bf16 v[64:79], v[116:119], v[20:23], v[64:79]
    s_waitcnt vmcnt(5)
    v_mfma_f32_32x32x16_bf16 v[48:63], v[88:91], v[24:27], v[48:63]
    v_mfma_f32_32x32x16_bf16 v[64:79], v[120:123], v[24:27], v[64:79]
    s_waitcnt vmcnt(4)
    v_mfma_f32_32x32x16_bf16 v[48:63], v[92:95], v[28:31], v[48:63]
    v_mfma_f32_32x32x16_bf16 v[64:79], v[124:127], v[28:31], v[64:79]
    s_waitcnt vmcnt(3)
    v_mfma_f32_32x32x16_bf16 v[48:63], v[96:99], v[32:35], v[48:63]
    v_mfma_f32_32x32x16_bf16 v[64:79], v[128:131], v[32:35], v[64:79]
    s_waitcnt vmcnt(2)
    v_mfma_f32_32x32x16_bf16 v[48:63], v[100:103], v[36:39], v[48:63]
    v_mfma_f32_32x32x16_bf16 v[64:79], v[132:135], v[36:39], v[64:79]
    s_waitcnt vmcnt(1)
    v_mfma_f32_32x32x16_bf16 v[48:63], v[104:107], v[40:43], v[48:63]
    v_mfma_f32_32x32x16_bf16 v[64:79], v[136:139], v[40:43], v[64:79]
    s_waitcnt vmcnt(0)
    v_mfma_f32_32x32x16_bf16 v[48:63], v[108:111], v[44:47], v[48:63]
    v_mfma_f32_32x32x16_bf16 v[64:79], v[140:143], v[44:47], v[64:79]
    s_nop 10
    ds_write_b128 v148, v[48:51] offset:0
    ds_write_b128 v149, v[52:55] offset:0
    ds_write_b128 v150, v[56:59] offset:0
    ds_write_b128 v151, v[60:63] offset:0
    ds_write_b128 v148, v[64:67] offset:4096
    ds_write_b128 v149, v[68:71] offset:4096
    ds_write_b128 v150, v[72:75] offset:4096
    ds_write_b128 v151, v[76:79] offset:4096
    s_mov_b64 exec, 1
    ds_add_u32 v147, v145 offset:60
    s_mov_b64 exec, -1
    s_mov_b32 s47, 0
L_cw56:
    ds_read_b32 v146, v147 offset:60
    s_add_u32 s47, s47, 1
    s_cmp_gt_u32 s47, 2097152
    s_cbranch_scc1 L_cd57
    s_waitcnt lgkmcnt(0)
    v_cmp_gt_u32 vcc, 8, v146
    s_nop 1
    s_cbranch_vccnz L_cw56
L_cd57:
    ds_read_b128 v[16:19], v152 offset:0
    ds_read_b128 v[20:23], v152 offset:16384
    ds_read_b128 v[24:27], v152 offset:32768
    ds_read_b128 v[28:31], v152 offset:49152
    ds_read_b128 v[32:35], v153 offset:512
    ds_read_b128 v[36:39], v153 offset:16896
    ds_read_b128 v[40:43], v153 offset:33280
    ds_read_b128 v[44:47], v153 offset:49664
    s_or_b32 s23, s2, s3
    s_cmp_eq_u32 s23, 0
    s_cbranch_scc0 L_NE
    s_add_u32 s23, s21, 1
    v_mov_b32 v3, s23
    s_mov_b64 exec, 1
    buffer_store_dword v3, off, s[12:15], 0 sc1
    s_mov_b64 exec, -1
L_NE:
    s_waitcnt lgkmcnt(6)
    v_pk_add_f32 v[16:17], v[16:17], v[20:21]
    v_pk_add_f32 v[18:19], v[18:19], v[22:23]
    s_waitcnt lgkmcnt(4)
    v_pk_add_f32 v[24:25], v[24:25], v[28:29]
    v_pk_add_f32 v[26:27], v[26:27], v[30:31]
    v_pk_add_f32 v[16:17], v[16:17], v[24:25]
    v_pk_add_f32 v[18:19], v[18:19], v[26:27]
    buffer_store_dwordx4 v[16:19], v154, s[36:39], s93 offen
    s_waitcnt lgkmcnt(2)
    v_pk_add_f32 v[32:33], v[32:33], v[36:37]
    v_pk_add_f32 v[34:35], v[34:35], v[38:39]
    s_waitcnt lgkmcnt(0)
    v_pk_add_f32 v[40:41], v[40:41], v[44:45]
    v_pk_add_f32 v[42:43], v[42:43], v[46:47]
    v_pk_add_f32 v[32:33], v[32:33], v[40:41]
    v_pk_add_f32 v[34:35], v[34:35], v[42:43]
    buffer_store_dwordx4 v[32:35], v154, s[36:39], s35 offen
L_END:
    s_endpgm
L_AWk:
    s_mov_b32 s47, 0
    s_setprio 0
L_AW2k:
    ds_read_b32 v3, v28
    s_add_u32 s47, s47, 1
    s_cmp_gt_u32 s47, 2097152
    s_cbranch_scc1 L_AW3k
    s_waitcnt lgkmcnt(0)
    v_cmp_gt_u32 vcc, 12, v3
    s_nop 1
    s_cbranch_vccnz L_AW2k
L_AW3k:
    s_setprio 2
    s_branch L_ARk
L_AWv:
    s_mov_b32 s47, 0
    s_setprio 0
L_AW2v:
    ds_read_b32 v3, v28
    s_add_u32 s47, s47, 1
    s_cmp_gt_u32 s47, 2097152
    s_cbranch_scc1 L_AW3v
    s_waitcnt lgkmcnt(0)
    v_cmp_gt_u32 vcc, 12, v3
    s_nop 1
    s_cbranch_vccnz L_AW2v
L_AW3v:
    s_setprio 1
    s_branch L_ARv
L_FB:
    s_waitcnt vmcnt(0)
    v_mov_b32 v29, 0xff800000
    s_mov_b32 s58, 0
    s_mov_b32 s23, s63
L_FB1:
    buffer_load_dwordx4 v[8:11], v144, s[12:15], s23 offen sc1
    s_waitcnt vmcnt(0)
    v_mfma_f32_32x32x16_bf16 v[32:47], v[8:11], v[4:7], 0
    s_nop 7
    s_nop 3
    v_max3_f32 v29, v29, v32, v33
    v_max3_f32 v29, v29, v34, v35
    v_max3_f32 v29, v29, v36, v37
    v_max3_f32 v29, v29, v38, v39
    v_max3_f32 v29, v29, v40, v41
    v_max3_f32 v29, v29, v42, v43
    v_max3_f32 v29, v29, v44, v45
    v_max3_f32 v29, v29, v46, v47
    s_add_u32 s23, s23, 2048
    s_add_u32 s58, s58, 1
    s_cmp_lt_u32 s58, 64
    s_cbranch_scc1 L_FB1
    v_mov_b32 v30, v29
    s_nop 1
    v_permlane32_swap_b32 v29, v30
    v_max_f32 v29, v29, v30
    s_mov_b32 s23, s63
    s_mov_b32 s58, 0
    v_xor_b32 v48, 0x80000000, v29
    v_mov_b32 v64, 0
    v_xor_b32 v49, 0x80000000, v29
    v_mov_b32 v65, 0
    v_xor_b32 v50, 0x80000000, v29
    v_mov_b32 v66, 0
    v_xor_b32 v51, 0x80000000, v29
    v_mov_b32 v67, 0
    v_xor_b32 v52, 0x80000000, v29
    v_mov_b32 v68, 0
    v_xor_b32 v53, 0x80000000, v29
    v_mov_b32 v69, 0
    v_xor_b32 v54, 0x80000000, v29
    v_mov_b32 v70, 0
    v_xor_b32 v55, 0x80000000, v29
    v_mov_b32 v71, 0
    v_xor_b32 v56, 0x80000000, v29
    v_mov_b32 v72, 0
    v_xor_b32 v57, 0x80000000, v29
    v_mov_b32 v73, 0
    v_xor_b32 v58, 0x80000000, v29
    v_mov_b32 v74, 0
    v_xor_b32 v59, 0x80000000, v29
    v_mov_b32 v75, 0
    v_xor_b32 v60, 0x80000000, v29
    v_mov_b32 v76, 0
    v_xor_b32 v61, 0x80000000, v29
    v_mov_b32 v77, 0
    v_xor_b32 v62, 0x80000000, v29
    v_mov_b32 v78, 0
    v_xor_b32 v63, 0x80000000, v29
    v_mov_b32 v79, 0
L_FB2:
    buffer_load_dwordx4 v[8:11], v144, s[12:15], s23 offen sc1
    s_mov_b64 exec, s[44:45]
    buffer_load_dwordx4 v[12:15], v144, s[12:15], s23 offen offset:1024 sc1
    buffer_load_dwordx4 v[16:19], v144, s[12:15], s23 offen offset:1280 sc1
    s_mov_b64 exec, -1
    s_waitcnt vmcnt(0)
    v_mfma_f32_32x32x16_bf16 v[32:47], v[8:11], v[4:7], v[48:63]
    s_nop 7
    s_nop 3
    v_exp_f32 v32, v32
    v_exp_f32 v33, v33
    v_exp_f32 v34, v34
    v_exp_f32 v35, v35
    v_exp_f32 v36, v36
    v_exp_f32 v37, v37
    v_exp_f32 v38, v38
    v_exp_f32 v39, v39
    v_exp_f32 v40, v40
    v_exp_f32 v41, v41
    v_exp_f32 v42, v42
    v_exp_f32 v43, v43
    v_exp_f32 v44, v44
    v_exp_f32 v45, v45
    v_exp_f32 v46, v46
    v_exp_f32 v47, v47
    s_nop 0
    v_cvt_pk_bf16_f32 v20, v32, v33
    v_cvt_pk_bf16_f32 v21, v34, v35
    v_cvt_pk_bf16_f32 v22, v36, v37
    v_cvt_pk_bf16_f32 v23, v38, v39
    v_cvt_pk_bf16_f32 v24, v40, v41
    v_cvt_pk_bf16_f32 v25, v42, v43
    v_cvt_pk_bf16_f32 v26, v44, v45
    v_cvt_pk_bf16_f32 v27, v46, v47
    s_nop 1
    v_mfma_f32_32x32x16_bf16 v[64:79], v[12:15], v[20:23], v[64:79]
    v_mfma_f32_32x32x16_bf16 v[64:79], v[16:19], v[24:27], v[64:79]
    s_add_u32 s23, s23, 2048
    s_add_u32 s58, s58, 1
    s_nop 7
    s_cmp_lt_u32 s58, 64
    s_cbranch_scc1 L_FB2
    s_nop 7
    v_mov_b32 v30, v72
    s_nop 1
    v_permlane32_swap_b32 v72, v30
    s_branch L_FBR
L_CODE_END:
.section .rodata,"a"
.p2align 6
.amdhsa_kernel concat_heads__ssm_conv_s5__mha_block__prompt_kernel
  .amdhsa_next_free_vgpr 168
  .amdhsa_next_free_sgpr 102
  .amdhsa_accum_offset 168
  .amdhsa_group_segment_fixed_size 0
  .amdhsa_kernarg_size 120
  .amdhsa_user_sgpr_count 2
  .amdhsa_user_sgpr_kernarg_segment_ptr 1
  .amdhsa_system_sgpr_workgroup_id_x 1
.end_amdhsa_kernel
```
